```python
import torch

def _softmax(x, axis=-1):
    return torch.softmax(x, dim=axis)
def _gelu(x):
    return torch.nn.functional.gelu(x, approximate="tanh")
def _silu(x):
    return torch.nn.functional.silu(x)
def _sigmoid(x):
    return torch.sigmoid(x)
def _layernorm(x, axis=-1, eps=1e-5):
    m = x.mean(dim=axis, keepdim=True)
    v = x.var(dim=axis, keepdim=True, unbiased=False)
    return (x - m) / torch.sqrt(v + eps)
def _scatter_add(tgt, idx, src, axis=0):
    return tgt.clone().index_add_(axis, idx, src)
def _segment_sum(src, seg, n):
    out = torch.zeros((n,) + src.shape[1:], dtype=src.dtype)
    return out.index_add_(0, seg, src)
def _pad(x, pw):
    flat = tuple(v for pair in reversed(pw) for v in pair)
    return torch.nn.functional.pad(x, flat)

kernel_name = 'standalone__weight_only_int_quip_2__prompt'

def setup_inputs():

    _w = (lambda a: (lambda t: t.to(torch.bfloat16) if t.is_floating_point() else t)(torch.as_tensor(a)))
    B, S, D, F = 1, 2048, 1024, 3584
    nbits = max(2, min(4, int(8)))
    G = 64 if 64 > 0 else D
    D = (D // G) * G
    ng = D // G
    qmax = 1 << nbits
    qw = torch.randint(0, qmax, (D, F)).to(torch.int32)
    zp = torch.randint(0, qmax, (ng, F)).to(float)
    sc = torch.abs((lambda *s: torch.randn(*s, dtype=torch.bfloat16) * 0.05)(ng, F)).to(float) * 0.1 + 0.02
    return {
        "x": _w((lambda *s: torch.randn(*s, dtype=torch.bfloat16) * 0.05)(B, S, D)),
        "qw": _w(qw),
        "scales": _w(sc),
        "zeros": _w(zp),
    }

def reference(x, qw, scales, zeros):
    B, S, D = x.shape
    ng, F = scales.shape
    G = D // ng
    s = (lambda x, n, axis: torch.repeat_interleave(x, n, dim=axis))(scales, G, axis=0)
    z = (lambda x, n, axis: torch.repeat_interleave(x, n, dim=axis))(zeros, G, axis=0)
    w = ((lambda x, dt: x.to(dt))(qw, x.dtype) - z) * s
    return torch.einsum("bsd,df->bsf", x, w)
```

```asm
; @launch grid=(256,1,1) block=(512,1,1) lds=156704
.amdgcn_target "amdgcn-amd-amdhsa--gfx950"
.text
.globl standalone__weight_only_int_quip_2__prompt_kernel
.p2align 8
.type standalone__weight_only_int_quip_2__prompt_kernel,@function
standalone__weight_only_int_quip_2__prompt_kernel:
    s_load_dwordx4 s[4:7], s[0:1], 0
    s_load_dwordx4 s[8:11], s[0:1], 16
    s_load_dwordx2 s[12:13], s[0:1], 32
    s_cmp_ge_u32 s2, 256
    s_cbranch_scc1 L_end
    s_getpc_b64 s[36:37]
L_pc:
    s_and_b32 s48, s2, 0x78
    v_lshrrev_b32_e64 v1, 6, v0
    s_mov_b32 s38, L_end-L_pc
    v_add_u32_e64 v2, s48, v1
    s_mov_b32 s39, 0x20000
    v_lshlrev_b32 v2, 7, v2
    s_mov_b64 exec, 1
    buffer_load_dword v248, v2, s[36:39], 0 offen
    s_mov_b64 exec, -1
    v_and_b32 v0, 63, v0
    s_and_b32 s48, s2, 7
    v_readfirstlane_b32 s44, v1
    s_lshr_b32 s49, s2, 3
    s_and_b32 s50, s48, 1
    s_lshl_b32 s50, s50, 2
    s_and_b32 s45, s49, 3
    s_add_u32 s45, s45, s50
    s_lshr_b32 s50, s48, 1
    s_lshl_b32 s50, s50, 3
    s_lshr_b32 s46, s49, 2
    s_add_u32 s46, s46, s50
    s_and_b32 s71, s46, 1
    s_lshr_b32 s48, s46, 1
    s_nop 0
    s_mul_i32 s41, s48, 448
    s_mul_i32 s48, s71, 192
    s_add_u32 s41, s41, s48
    s_lshl_b32 s40, s71, 16
    s_and_b32 s47, s44, 3
    s_and_b32 s48, s2, 7
    s_lshl_b32 s48, s48, 2
    s_nop 0
    s_lshr_b32 s99, 0x80808080, s48
    s_cmp_lt_u32 s44, 4
    s_cbranch_scc1 L_consumer
    s_setprio 1
    s_add_u32 s51, s45, s46
    s_and_b32 s51, s51, 3
    s_and_b32 s50, s46, 4
    s_or_b32 s51, s51, s50
    s_lshl_b32 s51, s51, 2
    s_lshr_b32 s60, 0x100210, s51
    s_add_u32 s60, s60, s99
    s_and_b32 s60, s60, 15
    v_lshrrev_b32 v10, 4, v0
    v_and_b32 v11, 15, v0
    v_mul_u32_u24 v10, 7168, v10
    v_lshl_add_u32 v1, v11, 4, v10
    s_mul_i32 s48, s47, 28672
    s_add_u32 s48, s48, s41
    s_lshl_b32 s50, s47, 10
    s_add_u32 s50, s50, 131072
    s_mov_b32 s26, 114688
    s_mov_b32 s27, 0x20000
    s_mov_b32 s22, 14680064
    s_mov_b32 s30, s26
    s_mov_b32 s31, s27
    s_mov_b32 s23, 0x74fac
    v_lshrrev_b32 v10, 5, v0
    v_and_b32 v11, 31, v0
    s_lshl_b32 s51, s47, 1
    v_add_u32 v12, s51, v10
    v_mul_u32_u24 v13, 114688, v12
    s_lshl_b32 s49, s41, 1
    s_nop 0
    v_lshl_add_u32 v13, v11, 4, v13
    v_add_u32_e64 v44, s49, v13
    s_mul_i32 s54, s60, 917504
    s_mov_b32 m0, s50
    s_waitcnt lgkmcnt(0)
    s_mov_b32 s24, s8
    s_mov_b32 s25, s9
    s_mov_b32 s28, s10
    s_mov_b32 s29, s11
    buffer_load_dwordx4 v1, s[24:27], s48 offen lds
    s_add_u32 m0, s50, 4096
    s_mov_b32 s20, s6
    s_mov_b32 s21, s7
    buffer_load_dwordx4 v1, s[28:31], s48 offen lds
    buffer_load_format_d16_xyzw v[52:53], v44, s[20:23], s54 offen
    v_add_u32 v45, 14336, v44
    buffer_load_format_d16_xyzw v[54:55], v45, s[20:23], s54 offen
    v_add_u32 v46, 28672, v44
    buffer_load_format_d16_xyzw v[56:57], v46, s[20:23], s54 offen
    v_add_u32 v47, 43008, v44
    buffer_load_format_d16_xyzw v[58:59], v47, s[20:23], s54 offen
    v_add_u32 v48, 57344, v44
    buffer_load_format_d16_xyzw v[60:61], v48, s[20:23], s54 offen
    v_add_u32 v49, 71680, v44
    buffer_load_format_d16_xyzw v[62:63], v49, s[20:23], s54 offen
    v_add_u32 v50, 86016, v44
    buffer_load_format_d16_xyzw v[64:65], v50, s[20:23], s54 offen
    v_add_u32 v51, 100352, v44
    buffer_load_format_d16_xyzw v[66:67], v51, s[20:23], s54 offen
    s_mov_b32 s16, s4
    s_mov_b32 s17, s5
    s_mov_b32 s18, 4194304
    s_mov_b32 s19, s27
    s_add_u32 s51, s45, s46
    s_and_b32 s51, s51, 3
    s_and_b32 s50, s46, 4
    s_or_b32 s51, s51, s50
    s_nop 0
    s_mov_b32 s58, 0x68532410
    s_mov_b32 s59, 0xfedbca97
    s_cmp_eq_u32 s51, 1
    s_nop 0
    s_cmov_b32 s58, 0x76435201
    s_cmov_b32 s59, 0xfecdba89
    s_cmp_eq_u32 s51, 2
    s_nop 0
    s_cmov_b32 s58, 0x75463102
    s_cmov_b32 s59, 0xfdecb9a8
    s_cmp_eq_u32 s51, 3
    s_nop 0
    s_cmov_b32 s58, 0x65742130
    s_cmov_b32 s59, 0xefdcab98
    s_cmp_eq_u32 s51, 4
    s_nop 0
    s_cmov_b32 s58, 0x86534210
    s_cmov_b32 s59, 0xfedbac97
    s_cmp_eq_u32 s51, 5
    s_nop 0
    s_cmov_b32 s58, 0x96453201
    s_cmov_b32 s59, 0xfecbda87
    s_cmp_eq_u32 s51, 6
    s_nop 0
    s_cmov_b32 s58, 0x75643120
    s_cmov_b32 s59, 0xfdceb98a
    s_cmp_eq_u32 s51, 7
    s_nop 0
    s_cmov_b32 s58, 0x67542310
    s_cmov_b32 s59, 0xedfca9b8
    s_and_b32 s48, s99, 8
    s_nop 0
    s_mul_i32 s48, s48, 0x11111111
    s_xor_b32 s58, s58, s48
    s_xor_b32 s59, s59, s48
    s_lshr_b64 s[58:59], s[58:59], 4
    s_lshl_b32 s51, s47, 1
    s_lshl_b32 s69, s60, 8
    s_lshl_b32 s68, s60, 7
    s_lshl_b32 s48, s45, 8
    s_lshl_b32 s49, s47, 6
    s_add_u32 s48, s48, s49
    s_lshl_b32 s48, s48, 11
    s_lshl_b32 s70, s47, 13
    v_lshrrev_b32 v10, 3, v0
    v_lshlrev_b32 v10, 11, v10
    v_add_u32 v10, s48, v10
    v_and_b32 v11, 7, v0
    v_lshrrev_b32 v12, 4, v0
    v_xor_b32_e64 v11, v11, v12
    v_lshl_add_u32 v2, v11, 4, v10
    v_xor_b32_e64 v3, 64, v2
    v_add_u32 v3, 15360, v3
    v_add_u32 v4, 30720, v2
    v_add_u32 v5, 30720, v3
    s_xor_b32 s48, s40, 65536
    v_add_u32 v104, s40, v2
    v_add_u32 v108, s48, v2
    v_add_u32 v105, s40, v3
    v_add_u32 v109, s48, v3
    v_add_u32 v106, s40, v4
    v_add_u32 v110, s48, v4
    v_add_u32 v107, s40, v5
    v_add_u32 v111, s48, v5
    v_lshrrev_b32 v10, 5, v0
    v_add_u32 v10, s51, v10
    v_lshrrev_b32 v11, 2, v10
    v_and_b32 v12, 31, v0
    v_lshrrev_b32 v13, 2, v12
    s_lshl_b32 s48, s71, 1
    v_subrev_u32 v14, s48, v13
    v_and_b32 v14, 7, v14
    v_lshl_add_u32 v11, v11, 3, v14
    v_and_b32 v10, 3, v10
    v_and_b32 v13, 1, v13
    v_lshlrev_b32_e64 v11, 10, v11
    v_lshl_add_u32 v11, v10, 8, v11
    v_and_b32_e64 v10, 3, v12
    v_lshl_add_u32 v11, v10, 4, v11
    v_lshl_add_u32 v11, v13, 6, v11
    v_add_u32 v7, 98304, v11
    v_xor_b32 v8, 64, v7
    v_lshlrev_b32 v9, 3, v12
    v_add_u32 v9, 131072, v9
    s_mov_b32 s56, 0xffff0000
    s_mov_b32 s61, 0
    s_nop 0
    s_mov_b32 s90, 32768
    s_mov_b32 s93, 65536
    s_mov_b32 s94, 917504
    s_mov_b32 s95, 4096
    s_mov_b32 s92, s70
    s_nop 0
    s_add_u32 s91, s70, 98304
    s_mov_b32 m0, s70
    s_nop 0
    s_mov_b32 s98, 0x4b800000
    v_mov_b32 v14, 0
    v_add_u32 v10, s69, v9
    s_waitcnt vmcnt(8)
    s_barrier
    ds_read_b64 v[40:41], v10
    ds_read_b64 v[42:43], v10 offset:4096
    s_waitcnt lgkmcnt(0)
    v_lshlrev_b32 v16, 16, v40
    v_and_b32_e64 v17, s56, v40
    buffer_load_dwordx4 v104, s[16:19], s68 offen lds
    s_and_b32 s60, s58, 15
    s_lshr_b64 s[58:59], s[58:59], 4
    v_lshlrev_b32 v18, 16, v41
    v_and_b32 v19, s56, v41
    v_lshlrev_b32 v20, 16, v42
    v_and_b32 v21, s56, v42
    buffer_load_dwordx4 v105, s[16:19], s68 offen offset:1024 lds
    v_lshlrev_b32 v22, 16, v43
    v_and_b32 v23, s56, v43
    v_mul_f32_e64 v20, -v20, v16
    v_mul_f32_e64 v21, -v21, v17
    buffer_load_dwordx4 v106, s[16:19], s68 offen offset:2048 lds
    v_mul_f32_e64 v22, -v22, v18
    v_mul_f32_e64 v23, -v23, v19
    v_mul_f32 v16, s98, v16
    v_mul_f32 v17, s98, v17
    buffer_load_dwordx4 v107, s[16:19], s68 offen offset:3072 lds
    v_mul_f32 v18, s98, v18
    v_mul_f32 v19, s98, v19
    v_lshl_add_u32 v10, s60, 8, v9
    ds_read_b64 v[40:41], v10
    ds_read_b64 v[42:43], v10 offset:4096
    s_add_u32 m0, s70, s95
    s_nop 0
    buffer_load_dwordx4 v108, s[16:19], s68 offen lds
    s_waitcnt vmcnt(11)
    s_mul_i32 s54, s60, s94
    v_fma_mix_f32 v88, v52, v16, v20 op_sel:[0,0,0] op_sel_hi:[1,0,0]
    v_fma_mix_f32 v89, v54, v16, v20 op_sel:[0,0,0] op_sel_hi:[1,0,0]
    v_fma_mix_f32 v90, v52, v17, v21 op_sel:[1,0,0] op_sel_hi:[1,0,0]
    v_fma_mix_f32 v91, v54, v17, v21 op_sel:[1,0,0] op_sel_hi:[1,0,0]
    buffer_load_dwordx4 v109, s[16:19], s68 offen offset:1024 lds
    v_fma_mix_f32 v92, v53, v18, v22 op_sel:[0,0,0] op_sel_hi:[1,0,0]
    v_fma_mix_f32 v93, v55, v18, v22 op_sel:[0,0,0] op_sel_hi:[1,0,0]
    v_fma_mix_f32 v94, v53, v19, v23 op_sel:[1,0,0] op_sel_hi:[1,0,0]
    v_fma_mix_f32 v95, v55, v19, v23 op_sel:[1,0,0] op_sel_hi:[1,0,0]
    v_or3_b32 v14, v14, v52, v53
    v_or3_b32 v14, v14, v54, v55
    buffer_load_dwordx4 v110, s[16:19], s68 offen offset:2048 lds
    v_cvt_pk_bf16_f32 v120, v88, v89
    v_cvt_pk_bf16_f32 v124, v90, v91
    v_cvt_pk_bf16_f32 v128, v92, v93
    v_cvt_pk_bf16_f32 v132, v94, v95
    s_waitcnt vmcnt(11)
    s_add_u32 s49, s70, s90
    v_fma_mix_f32 v96, v56, v16, v20 op_sel:[0,0,0] op_sel_hi:[1,0,0]
    v_fma_mix_f32 v97, v58, v16, v20 op_sel:[0,0,0] op_sel_hi:[1,0,0]
    v_fma_mix_f32 v98, v56, v17, v21 op_sel:[1,0,0] op_sel_hi:[1,0,0]
    v_fma_mix_f32 v99, v58, v17, v21 op_sel:[1,0,0] op_sel_hi:[1,0,0]
    buffer_load_dwordx4 v111, s[16:19], s68 offen offset:3072 lds
    s_cmp_eq_u32 s49, s91
    s_cselect_b32 s70, s92, s49
    s_mov_b32 m0, s70
    s_lshl_b32 s68, s60, 7
    buffer_load_format_d16_xyzw v[68:69], v44, s[20:23], s54 offen
    v_fma_mix_f32 v100, v57, v18, v22 op_sel:[0,0,0] op_sel_hi:[1,0,0]
    v_fma_mix_f32 v101, v59, v18, v22 op_sel:[0,0,0] op_sel_hi:[1,0,0]
    v_fma_mix_f32 v102, v57, v19, v23 op_sel:[1,0,0] op_sel_hi:[1,0,0]
    v_fma_mix_f32 v103, v59, v19, v23 op_sel:[1,0,0] op_sel_hi:[1,0,0]
    buffer_load_format_d16_xyzw v[70:71], v45, s[20:23], s54 offen
    v_or3_b32 v14, v14, v56, v57
    v_or3_b32 v14, v14, v58, v59
    v_cvt_pk_bf16_f32 v121, v96, v97
    v_cvt_pk_bf16_f32 v125, v98, v99
    buffer_load_format_d16_xyzw v[72:73], v46, s[20:23], s54 offen
    v_cvt_pk_bf16_f32 v129, v100, v101
    v_cvt_pk_bf16_f32 v133, v102, v103
    buffer_load_format_d16_xyzw v[74:75], v47, s[20:23], s54 offen
    s_waitcnt vmcnt(14)
    s_nop 0
    v_fma_mix_f32 v88, v60, v16, v20 op_sel:[0,0,0] op_sel_hi:[1,0,0]
    v_fma_mix_f32 v89, v62, v16, v20 op_sel:[0,0,0] op_sel_hi:[1,0,0]
    v_fma_mix_f32 v90, v60, v17, v21 op_sel:[1,0,0] op_sel_hi:[1,0,0]
    v_fma_mix_f32 v91, v62, v17, v21 op_sel:[1,0,0] op_sel_hi:[1,0,0]
    v_fma_mix_f32 v92, v61, v18, v22 op_sel:[0,0,0] op_sel_hi:[1,0,0]
    v_fma_mix_f32 v93, v63, v18, v22 op_sel:[0,0,0] op_sel_hi:[1,0,0]
    buffer_load_format_d16_xyzw v[76:77], v48, s[20:23], s54 offen
    v_fma_mix_f32 v94, v61, v19, v23 op_sel:[1,0,0] op_sel_hi:[1,0,0]
    v_fma_mix_f32 v95, v63, v19, v23 op_sel:[1,0,0] op_sel_hi:[1,0,0]
    v_or3_b32 v14, v14, v60, v61
    v_or3_b32 v14, v14, v62, v63
    v_cvt_pk_bf16_f32 v122, v88, v89
    v_cvt_pk_bf16_f32 v126, v90, v91
    buffer_load_format_d16_xyzw v[78:79], v49, s[20:23], s54 offen
    v_cvt_pk_bf16_f32 v130, v92, v93
    v_cvt_pk_bf16_f32 v134, v94, v95
    s_waitcnt vmcnt(14)
    s_nop 0
    v_fma_mix_f32 v96, v64, v16, v20 op_sel:[0,0,0] op_sel_hi:[1,0,0]
    v_fma_mix_f32 v97, v66, v16, v20 op_sel:[0,0,0] op_sel_hi:[1,0,0]
    v_fma_mix_f32 v98, v64, v17, v21 op_sel:[1,0,0] op_sel_hi:[1,0,0]
    v_fma_mix_f32 v99, v66, v17, v21 op_sel:[1,0,0] op_sel_hi:[1,0,0]
    buffer_load_format_d16_xyzw v[80:81], v50, s[20:23], s54 offen
    v_fma_mix_f32 v100, v65, v18, v22 op_sel:[0,0,0] op_sel_hi:[1,0,0]
    v_fma_mix_f32 v101, v67, v18, v22 op_sel:[0,0,0] op_sel_hi:[1,0,0]
    v_fma_mix_f32 v102, v65, v19, v23 op_sel:[1,0,0] op_sel_hi:[1,0,0]
    v_fma_mix_f32 v103, v67, v19, v23 op_sel:[1,0,0] op_sel_hi:[1,0,0]
    v_or3_b32 v14, v14, v64, v65
    v_or3_b32 v14, v14, v66, v67
    v_cvt_pk_bf16_f32 v123, v96, v97
    v_cvt_pk_bf16_f32 v127, v98, v99
    buffer_load_format_d16_xyzw v[82:83], v51, s[20:23], s54 offen
    v_cvt_pk_bf16_f32 v131, v100, v101
    v_cvt_pk_bf16_f32 v135, v102, v103
    s_waitcnt lgkmcnt(0)
    s_nop 0
L_ploop:
    ds_write_b128 v7, v[120:123]
    v_lshlrev_b32 v16, 16, v40
    v_and_b32 v17, s56, v40
    buffer_load_dwordx4 v104, s[16:19], s68 offen lds
    s_and_b32 s60, s58, 15
    s_lshr_b64 s[58:59], s[58:59], 4
    v_lshlrev_b32 v18, 16, v41
    v_and_b32 v19, s56, v41
    ds_write_b128 v8, v[124:127]
    v_lshlrev_b32 v20, 16, v42
    v_and_b32 v21, s56, v42
    buffer_load_dwordx4 v105, s[16:19], s68 offen offset:1024 lds
    v_lshlrev_b32 v22, 16, v43
    v_and_b32 v23, s56, v43
    v_mul_f32_e64 v20, -v20, v16
    ds_write_b128 v7, v[128:131] offset:128
    v_mul_f32_e64 v21, -v21, v17
    buffer_load_dwordx4 v106, s[16:19], s68 offen offset:2048 lds
    v_mul_f32_e64 v22, -v22, v18
    v_mul_f32_e64 v23, -v23, v19
    v_mul_f32_e64 v16, s98, v16
    ds_write_b128 v8, v[132:135] offset:128
    v_mul_f32_e64 v17, s98, v17
    buffer_load_dwordx4 v107, s[16:19], s68 offen offset:3072 lds
    v_mul_f32 v18, s98, v18
    v_mul_f32 v19, s98, v19
    v_lshl_add_u32 v10, s60, 8, v9
    ds_read_b64 v[40:41], v10
    ds_read_b64 v[42:43], v10 offset:4096
    s_add_u32 m0, s70, s95
    s_nop 0
    buffer_load_dwordx4 v108, s[16:19], s68 offen lds
    s_waitcnt vmcnt(11)
    s_mul_i32 s54, s60, s94
    v_fma_mix_f32 v88, v68, v16, v20 op_sel:[0,0,0] op_sel_hi:[1,0,0]
    v_fma_mix_f32 v89, v70, v16, v20 op_sel:[0,0,0] op_sel_hi:[1,0,0]
    v_fma_mix_f32 v90, v68, v17, v21 op_sel:[1,0,0] op_sel_hi:[1,0,0]
    v_fma_mix_f32 v91, v70, v17, v21 op_sel:[1,0,0] op_sel_hi:[1,0,0]
    buffer_load_dwordx4 v109, s[16:19], s68 offen offset:1024 lds
    v_fma_mix_f32 v92, v69, v18, v22 op_sel:[0,0,0] op_sel_hi:[1,0,0]
    v_fma_mix_f32 v93, v71, v18, v22 op_sel:[0,0,0] op_sel_hi:[1,0,0]
    v_fma_mix_f32 v94, v69, v19, v23 op_sel:[1,0,0] op_sel_hi:[1,0,0]
    v_fma_mix_f32 v95, v71, v19, v23 op_sel:[1,0,0] op_sel_hi:[1,0,0]
    v_or3_b32 v14, v14, v68, v69
    v_or3_b32 v14, v14, v70, v71
    buffer_load_dwordx4 v110, s[16:19], s68 offen offset:2048 lds
    v_cvt_pk_bf16_f32 v136, v88, v89
    v_cvt_pk_bf16_f32 v140, v90, v91
    v_cvt_pk_bf16_f32 v144, v92, v93
    v_cvt_pk_bf16_f32 v148, v94, v95
    s_waitcnt vmcnt(11)
    s_add_u32 s49, s70, s90
    v_fma_mix_f32 v96, v72, v16, v20 op_sel:[0,0,0] op_sel_hi:[1,0,0]
    v_fma_mix_f32 v97, v74, v16, v20 op_sel:[0,0,0] op_sel_hi:[1,0,0]
    v_fma_mix_f32 v98, v72, v17, v21 op_sel:[1,0,0] op_sel_hi:[1,0,0]
    v_fma_mix_f32 v99, v74, v17, v21 op_sel:[1,0,0] op_sel_hi:[1,0,0]
    buffer_load_dwordx4 v111, s[16:19], s68 offen offset:3072 lds
    s_cmp_eq_u32 s49, s91
    s_cselect_b32 s70, s92, s49
    s_mov_b32 m0, s70
    s_lshl_b32 s68, s60, 7
    buffer_load_format_d16_xyzw v[52:53], v44, s[20:23], s54 offen
    v_fma_mix_f32 v100, v73, v18, v22 op_sel:[0,0,0] op_sel_hi:[1,0,0]
    v_fma_mix_f32 v101, v75, v18, v22 op_sel:[0,0,0] op_sel_hi:[1,0,0]
    v_fma_mix_f32 v102, v73, v19, v23 op_sel:[1,0,0] op_sel_hi:[1,0,0]
    v_fma_mix_f32 v103, v75, v19, v23 op_sel:[1,0,0] op_sel_hi:[1,0,0]
    buffer_load_format_d16_xyzw v[54:55], v45, s[20:23], s54 offen
    v_or3_b32 v14, v14, v72, v73
    v_or3_b32 v14, v14, v74, v75
    v_cvt_pk_bf16_f32 v137, v96, v97
    v_cvt_pk_bf16_f32 v141, v98, v99
    buffer_load_format_d16_xyzw v[56:57], v46, s[20:23], s54 offen
    v_cvt_pk_bf16_f32 v145, v100, v101
    v_cvt_pk_bf16_f32 v149, v102, v103
    buffer_load_format_d16_xyzw v[58:59], v47, s[20:23], s54 offen
    s_waitcnt vmcnt(14)
    s_add_u32 s61, s61, 1
    v_fma_mix_f32 v88, v76, v16, v20 op_sel:[0,0,0] op_sel_hi:[1,0,0]
    v_fma_mix_f32 v89, v78, v16, v20 op_sel:[0,0,0] op_sel_hi:[1,0,0]
    v_fma_mix_f32 v90, v76, v17, v21 op_sel:[1,0,0] op_sel_hi:[1,0,0]
    v_fma_mix_f32 v91, v78, v17, v21 op_sel:[1,0,0] op_sel_hi:[1,0,0]
    v_fma_mix_f32 v92, v77, v18, v22 op_sel:[0,0,0] op_sel_hi:[1,0,0]
    v_fma_mix_f32 v93, v79, v18, v22 op_sel:[0,0,0] op_sel_hi:[1,0,0]
    buffer_load_format_d16_xyzw v[60:61], v48, s[20:23], s54 offen
    v_fma_mix_f32 v94, v77, v19, v23 op_sel:[1,0,0] op_sel_hi:[1,0,0]
    v_fma_mix_f32 v95, v79, v19, v23 op_sel:[1,0,0] op_sel_hi:[1,0,0]
    v_or3_b32 v14, v14, v76, v77
    v_or3_b32 v14, v14, v78, v79
    v_cvt_pk_bf16_f32 v138, v88, v89
    v_cvt_pk_bf16_f32 v142, v90, v91
    buffer_load_format_d16_xyzw v[62:63], v49, s[20:23], s54 offen
    v_cvt_pk_bf16_f32 v146, v92, v93
    v_cvt_pk_bf16_f32 v150, v94, v95
    s_waitcnt vmcnt(14)
    s_nop 0
    v_fma_mix_f32 v96, v80, v16, v20 op_sel:[0,0,0] op_sel_hi:[1,0,0]
    v_fma_mix_f32 v97, v82, v16, v20 op_sel:[0,0,0] op_sel_hi:[1,0,0]
    v_fma_mix_f32 v98, v80, v17, v21 op_sel:[1,0,0] op_sel_hi:[1,0,0]
    v_fma_mix_f32 v99, v82, v17, v21 op_sel:[1,0,0] op_sel_hi:[1,0,0]
    buffer_load_format_d16_xyzw v[64:65], v50, s[20:23], s54 offen
    v_fma_mix_f32 v100, v81, v18, v22 op_sel:[0,0,0] op_sel_hi:[1,0,0]
    v_fma_mix_f32 v101, v83, v18, v22 op_sel:[0,0,0] op_sel_hi:[1,0,0]
    v_fma_mix_f32 v102, v81, v19, v23 op_sel:[1,0,0] op_sel_hi:[1,0,0]
    v_fma_mix_f32 v103, v83, v19, v23 op_sel:[1,0,0] op_sel_hi:[1,0,0]
    v_or3_b32 v14, v14, v80, v81
    v_or3_b32 v14, v14, v82, v83
    v_cvt_pk_bf16_f32 v139, v96, v97
    v_cvt_pk_bf16_f32 v143, v98, v99
    buffer_load_format_d16_xyzw v[66:67], v51, s[20:23], s54 offen
    v_cvt_pk_bf16_f32 v147, v100, v101
    v_cvt_pk_bf16_f32 v151, v102, v103
    s_waitcnt lgkmcnt(0)
    s_barrier
    ds_write_b128 v7, v[136:139] offset:16384
    v_lshlrev_b32 v16, 16, v40
    v_and_b32 v17, s56, v40
    buffer_load_dwordx4 v104, s[16:19], s68 offen lds
    s_and_b32 s60, s58, 15
    s_lshr_b64 s[58:59], s[58:59], 4
    v_lshlrev_b32 v18, 16, v41
    v_and_b32 v19, s56, v41
    ds_write_b128 v8, v[140:143] offset:16384
    v_lshlrev_b32 v20, 16, v42
    v_and_b32 v21, s56, v42
    buffer_load_dwordx4 v105, s[16:19], s68 offen offset:1024 lds
    v_lshlrev_b32 v22, 16, v43
    v_and_b32 v23, s56, v43
    v_mul_f32_e64 v20, -v20, v16
    ds_write_b128 v7, v[144:147] offset:16512
    v_mul_f32_e64 v21, -v21, v17
    buffer_load_dwordx4 v106, s[16:19], s68 offen offset:2048 lds
    v_mul_f32_e64 v22, -v22, v18
    v_mul_f32_e64 v23, -v23, v19
    v_mul_f32_e64 v16, s98, v16
    ds_write_b128 v8, v[148:151] offset:16512
    v_mul_f32_e64 v17, s98, v17
    buffer_load_dwordx4 v107, s[16:19], s68 offen offset:3072 lds
    v_mul_f32 v18, s98, v18
    v_mul_f32 v19, s98, v19
    v_lshl_add_u32 v10, s60, 8, v9
    ds_read_b64 v[40:41], v10
    ds_read_b64 v[42:43], v10 offset:4096
    s_add_u32 m0, s70, s95
    s_nop 0
    buffer_load_dwordx4 v108, s[16:19], s68 offen lds
    s_waitcnt vmcnt(11)
    s_mul_i32 s54, s60, s94
    v_fma_mix_f32 v88, v52, v16, v20 op_sel:[0,0,0] op_sel_hi:[1,0,0]
    v_fma_mix_f32 v89, v54, v16, v20 op_sel:[0,0,0] op_sel_hi:[1,0,0]
    v_fma_mix_f32 v90, v52, v17, v21 op_sel:[1,0,0] op_sel_hi:[1,0,0]
    v_fma_mix_f32 v91, v54, v17, v21 op_sel:[1,0,0] op_sel_hi:[1,0,0]
    buffer_load_dwordx4 v109, s[16:19], s68 offen offset:1024 lds
    v_fma_mix_f32 v92, v53, v18, v22 op_sel:[0,0,0] op_sel_hi:[1,0,0]
    v_fma_mix_f32 v93, v55, v18, v22 op_sel:[0,0,0] op_sel_hi:[1,0,0]
    v_fma_mix_f32 v94, v53, v19, v23 op_sel:[1,0,0] op_sel_hi:[1,0,0]
    v_fma_mix_f32 v95, v55, v19, v23 op_sel:[1,0,0] op_sel_hi:[1,0,0]
    v_or3_b32 v14, v14, v52, v53
    v_or3_b32 v14, v14, v54, v55
    buffer_load_dwordx4 v110, s[16:19], s68 offen offset:2048 lds
    v_cvt_pk_bf16_f32 v120, v88, v89
    v_cvt_pk_bf16_f32 v124, v90, v91
    v_cvt_pk_bf16_f32 v128, v92, v93
    v_cvt_pk_bf16_f32 v132, v94, v95
    s_waitcnt vmcnt(11)
    s_add_u32 s49, s70, s90
    v_fma_mix_f32 v96, v56, v16, v20 op_sel:[0,0,0] op_sel_hi:[1,0,0]
    v_fma_mix_f32 v97, v58, v16, v20 op_sel:[0,0,0] op_sel_hi:[1,0,0]
    v_fma_mix_f32 v98, v56, v17, v21 op_sel:[1,0,0] op_sel_hi:[1,0,0]
    v_fma_mix_f32 v99, v58, v17, v21 op_sel:[1,0,0] op_sel_hi:[1,0,0]
    buffer_load_dwordx4 v111, s[16:19], s68 offen offset:3072 lds
    s_cmp_eq_u32 s49, s91
    s_cselect_b32 s70, s92, s49
    s_mov_b32 m0, s70
    s_lshl_b32 s68, s60, 7
    buffer_load_format_d16_xyzw v[68:69], v44, s[20:23], s54 offen
    v_fma_mix_f32 v100, v57, v18, v22 op_sel:[0,0,0] op_sel_hi:[1,0,0]
    v_fma_mix_f32 v101, v59, v18, v22 op_sel:[0,0,0] op_sel_hi:[1,0,0]
    v_fma_mix_f32 v102, v57, v19, v23 op_sel:[1,0,0] op_sel_hi:[1,0,0]
    v_fma_mix_f32 v103, v59, v19, v23 op_sel:[1,0,0] op_sel_hi:[1,0,0]
    buffer_load_format_d16_xyzw v[70:71], v45, s[20:23], s54 offen
    v_or3_b32 v14, v14, v56, v57
    v_or3_b32 v14, v14, v58, v59
    v_cvt_pk_bf16_f32 v121, v96, v97
    v_cvt_pk_bf16_f32 v125, v98, v99
    buffer_load_format_d16_xyzw v[72:73], v46, s[20:23], s54 offen
    v_cvt_pk_bf16_f32 v129, v100, v101
    v_cvt_pk_bf16_f32 v133, v102, v103
    buffer_load_format_d16_xyzw v[74:75], v47, s[20:23], s54 offen
    s_waitcnt vmcnt(14)
    s_add_u32 s61, s61, 1
    v_fma_mix_f32 v88, v60, v16, v20 op_sel:[0,0,0] op_sel_hi:[1,0,0]
    v_fma_mix_f32 v89, v62, v16, v20 op_sel:[0,0,0] op_sel_hi:[1,0,0]
    v_fma_mix_f32 v90, v60, v17, v21 op_sel:[1,0,0] op_sel_hi:[1,0,0]
    v_fma_mix_f32 v91, v62, v17, v21 op_sel:[1,0,0] op_sel_hi:[1,0,0]
    v_fma_mix_f32 v92, v61, v18, v22 op_sel:[0,0,0] op_sel_hi:[1,0,0]
    v_fma_mix_f32 v93, v63, v18, v22 op_sel:[0,0,0] op_sel_hi:[1,0,0]
    buffer_load_format_d16_xyzw v[76:77], v48, s[20:23], s54 offen
    v_fma_mix_f32 v94, v61, v19, v23 op_sel:[1,0,0] op_sel_hi:[1,0,0]
    v_fma_mix_f32 v95, v63, v19, v23 op_sel:[1,0,0] op_sel_hi:[1,0,0]
    v_or3_b32 v14, v14, v60, v61
    v_or3_b32 v14, v14, v62, v63
    v_cvt_pk_bf16_f32 v122, v88, v89
    v_cvt_pk_bf16_f32 v126, v90, v91
    buffer_load_format_d16_xyzw v[78:79], v49, s[20:23], s54 offen
    v_cvt_pk_bf16_f32 v130, v92, v93
    v_cvt_pk_bf16_f32 v134, v94, v95
    s_waitcnt vmcnt(14)
    s_cmp_lt_u32 s61, 14
    v_fma_mix_f32 v96, v64, v16, v20 op_sel:[0,0,0] op_sel_hi:[1,0,0]
    v_fma_mix_f32 v97, v66, v16, v20 op_sel:[0,0,0] op_sel_hi:[1,0,0]
    v_fma_mix_f32 v98, v64, v17, v21 op_sel:[1,0,0] op_sel_hi:[1,0,0]
    v_fma_mix_f32 v99, v66, v17, v21 op_sel:[1,0,0] op_sel_hi:[1,0,0]
    buffer_load_format_d16_xyzw v[80:81], v50, s[20:23], s54 offen
    v_fma_mix_f32 v100, v65, v18, v22 op_sel:[0,0,0] op_sel_hi:[1,0,0]
    v_fma_mix_f32 v101, v67, v18, v22 op_sel:[0,0,0] op_sel_hi:[1,0,0]
    v_fma_mix_f32 v102, v65, v19, v23 op_sel:[1,0,0] op_sel_hi:[1,0,0]
    v_fma_mix_f32 v103, v67, v19, v23 op_sel:[1,0,0] op_sel_hi:[1,0,0]
    v_or3_b32 v14, v14, v64, v65
    v_or3_b32 v14, v14, v66, v67
    v_cvt_pk_bf16_f32 v123, v96, v97
    v_cvt_pk_bf16_f32 v127, v98, v99
    buffer_load_format_d16_xyzw v[82:83], v51, s[20:23], s54 offen
    v_cvt_pk_bf16_f32 v131, v100, v101
    v_cvt_pk_bf16_f32 v135, v102, v103
    s_waitcnt lgkmcnt(0)
    s_barrier
    s_cbranch_scc1 L_ploop
    s_nop 0
    ds_write_b128 v7, v[120:123]
    v_lshlrev_b32 v16, 16, v40
    v_and_b32 v17, s56, v40
    buffer_load_dwordx4 v104, s[16:19], s68 offen lds
    v_lshlrev_b32 v18, 16, v41
    v_and_b32 v19, s56, v41
    ds_write_b128 v8, v[124:127]
    v_lshlrev_b32 v20, 16, v42
    v_and_b32 v21, s56, v42
    buffer_load_dwordx4 v105, s[16:19], s68 offen offset:1024 lds
    v_lshlrev_b32 v22, 16, v43
    v_and_b32 v23, s56, v43
    v_mul_f32_e64 v20, -v20, v16
    ds_write_b128 v7, v[128:131] offset:128
    v_mul_f32_e64 v21, -v21, v17
    buffer_load_dwordx4 v106, s[16:19], s68 offen offset:2048 lds
    v_mul_f32_e64 v22, -v22, v18
    v_mul_f32_e64 v23, -v23, v19
    v_mul_f32_e64 v16, s98, v16
    ds_write_b128 v8, v[132:135] offset:128
    v_mul_f32_e64 v17, s98, v17
    buffer_load_dwordx4 v107, s[16:19], s68 offen offset:3072 lds
    v_mul_f32 v18, s98, v18
    v_mul_f32 v19, s98, v19
    s_add_u32 m0, s70, s95
    s_nop 0
    buffer_load_dwordx4 v108, s[16:19], s68 offen lds
    s_waitcnt vmcnt(11)
    s_nop 0
    v_fma_mix_f32 v88, v68, v16, v20 op_sel:[0,0,0] op_sel_hi:[1,0,0]
    v_fma_mix_f32 v89, v70, v16, v20 op_sel:[0,0,0] op_sel_hi:[1,0,0]
    v_fma_mix_f32 v90, v68, v17, v21 op_sel:[1,0,0] op_sel_hi:[1,0,0]
    v_fma_mix_f32 v91, v70, v17, v21 op_sel:[1,0,0] op_sel_hi:[1,0,0]
    buffer_load_dwordx4 v109, s[16:19], s68 offen offset:1024 lds
    v_fma_mix_f32 v92, v69, v18, v22 op_sel:[0,0,0] op_sel_hi:[1,0,0]
    v_fma_mix_f32 v93, v71, v18, v22 op_sel:[0,0,0] op_sel_hi:[1,0,0]
    v_fma_mix_f32 v94, v69, v19, v23 op_sel:[1,0,0] op_sel_hi:[1,0,0]
    v_fma_mix_f32 v95, v71, v19, v23 op_sel:[1,0,0] op_sel_hi:[1,0,0]
    v_or3_b32 v14, v14, v68, v69
    v_or3_b32 v14, v14, v70, v71
    buffer_load_dwordx4 v110, s[16:19], s68 offen offset:2048 lds
    v_cvt_pk_bf16_f32 v136, v88, v89
    v_cvt_pk_bf16_f32 v140, v90, v91
    v_cvt_pk_bf16_f32 v144, v92, v93
    v_cvt_pk_bf16_f32 v148, v94, v95
    s_waitcnt vmcnt(11)
    s_add_u32 s49, s70, s90
    v_fma_mix_f32 v96, v72, v16, v20 op_sel:[0,0,0] op_sel_hi:[1,0,0]
    v_fma_mix_f32 v97, v74, v16, v20 op_sel:[0,0,0] op_sel_hi:[1,0,0]
    v_fma_mix_f32 v98, v72, v17, v21 op_sel:[1,0,0] op_sel_hi:[1,0,0]
    v_fma_mix_f32 v99, v74, v17, v21 op_sel:[1,0,0] op_sel_hi:[1,0,0]
    buffer_load_dwordx4 v111, s[16:19], s68 offen offset:3072 lds
    s_cmp_eq_u32 s49, s91
    s_cselect_b32 s70, s92, s49
    s_mov_b32 m0, s70
    s_nop 0
    v_fma_mix_f32 v100, v73, v18, v22 op_sel:[0,0,0] op_sel_hi:[1,0,0]
    v_fma_mix_f32 v101, v75, v18, v22 op_sel:[0,0,0] op_sel_hi:[1,0,0]
    v_fma_mix_f32 v102, v73, v19, v23 op_sel:[1,0,0] op_sel_hi:[1,0,0]
    v_fma_mix_f32 v103, v75, v19, v23 op_sel:[1,0,0] op_sel_hi:[1,0,0]
    v_or3_b32 v14, v14, v72, v73
    v_or3_b32 v14, v14, v74, v75
    v_cvt_pk_bf16_f32 v137, v96, v97
    v_cvt_pk_bf16_f32 v141, v98, v99
    v_cvt_pk_bf16_f32 v145, v100, v101
    v_cvt_pk_bf16_f32 v149, v102, v103
    s_waitcnt vmcnt(10)
    s_add_u32 s61, s61, 1
    v_fma_mix_f32 v88, v76, v16, v20 op_sel:[0,0,0] op_sel_hi:[1,0,0]
    v_fma_mix_f32 v89, v78, v16, v20 op_sel:[0,0,0] op_sel_hi:[1,0,0]
    v_fma_mix_f32 v90, v76, v17, v21 op_sel:[1,0,0] op_sel_hi:[1,0,0]
    v_fma_mix_f32 v91, v78, v17, v21 op_sel:[1,0,0] op_sel_hi:[1,0,0]
    v_fma_mix_f32 v92, v77, v18, v22 op_sel:[0,0,0] op_sel_hi:[1,0,0]
    v_fma_mix_f32 v93, v79, v18, v22 op_sel:[0,0,0] op_sel_hi:[1,0,0]
    v_fma_mix_f32 v94, v77, v19, v23 op_sel:[1,0,0] op_sel_hi:[1,0,0]
    v_fma_mix_f32 v95, v79, v19, v23 op_sel:[1,0,0] op_sel_hi:[1,0,0]
    v_or3_b32 v14, v14, v76, v77
    v_or3_b32 v14, v14, v78, v79
    v_cvt_pk_bf16_f32 v138, v88, v89
    v_cvt_pk_bf16_f32 v142, v90, v91
    v_cvt_pk_bf16_f32 v146, v92, v93
    v_cvt_pk_bf16_f32 v150, v94, v95
    s_waitcnt vmcnt(8)
    s_nop 0
    v_fma_mix_f32 v96, v80, v16, v20 op_sel:[0,0,0] op_sel_hi:[1,0,0]
    v_fma_mix_f32 v97, v82, v16, v20 op_sel:[0,0,0] op_sel_hi:[1,0,0]
    v_fma_mix_f32 v98, v80, v17, v21 op_sel:[1,0,0] op_sel_hi:[1,0,0]
    v_fma_mix_f32 v99, v82, v17, v21 op_sel:[1,0,0] op_sel_hi:[1,0,0]
    v_fma_mix_f32 v100, v81, v18, v22 op_sel:[0,0,0] op_sel_hi:[1,0,0]
    v_fma_mix_f32 v101, v83, v18, v22 op_sel:[0,0,0] op_sel_hi:[1,0,0]
    v_fma_mix_f32 v102, v81, v19, v23 op_sel:[1,0,0] op_sel_hi:[1,0,0]
    v_fma_mix_f32 v103, v83, v19, v23 op_sel:[1,0,0] op_sel_hi:[1,0,0]
    v_or3_b32 v14, v14, v80, v81
    v_or3_b32 v14, v14, v82, v83
    v_cvt_pk_bf16_f32 v139, v96, v97
    v_cvt_pk_bf16_f32 v143, v98, v99
    v_cvt_pk_bf16_f32 v147, v100, v101
    v_cvt_pk_bf16_f32 v151, v102, v103
    s_waitcnt lgkmcnt(0)
    s_barrier
    ds_write_b128 v7, v[136:139] offset:16384
    ds_write_b128 v8, v[140:143] offset:16384
    ds_write_b128 v7, v[144:147] offset:16512
    ds_write_b128 v8, v[148:151] offset:16512
    v_and_b32 v14, 0xf800f800, v14
    v_cmp_ne_u32 vcc, 0, v14
    s_lshl_b32 s48, s44, 2
    s_add_u32 s48, s48, 156672
    v_mov_b32 v10, s48
    s_or_b32 s49, vcc_lo, vcc_hi
    v_mov_b32_e64 v11, s49
    ds_write_b32 v10, v11
    s_add_u32 s61, s61, 1
    s_waitcnt vmcnt(0) lgkmcnt(0)
    s_barrier
    s_nop 0
    v_mbcnt_lo_u32_b32 v10, -1, 0
    v_and_b32 v10, 7, v10
    v_lshlrev_b32 v10, 2, v10
    v_add_u32 v10, 0x20000, v10
    ds_read_b32 v10, v10 offset:25600
    s_waitcnt lgkmcnt(0)
    v_cmp_ne_u32 vcc, 0, v10
    s_nop 4
    s_cbranch_vccnz L_fallback
    v_lshrrev_b32 v10, 4, v0
    v_and_b32 v11, 15, v0
    v_mul_u32_u24 v12, 272, v10
    v_lshl_add_u32 v12, v11, 4, v12
    s_lshl_b32 s48, s47, 13
    s_nop 0
    s_add_u32 s48, s48, 32768
    s_mul_i32 s49, s47, 4352
    s_add_u32 s49, s49, 139264
    v_add_u32 v13, s48, v12
    v_add_u32 v14, s49, v12
    s_lshl_b32 s49, s45, 8
    s_lshl_b32 s50, s47, 6
    s_add_u32 s49, s49, s50
    s_lshl_b32 s50, s71, 5
    s_add_u32 s49, s49, s50
    s_nop 0
    s_mul_i32 s49, s49, 7168
    s_add_u32 s49, s49, s41
    s_lshl_b32 s50, s71, 2
    v_add_u32 v11, s50, v11
    v_and_b32 v11, 15, v11
    v_lshlrev_b32_e64 v11, 4, v11
    v_mul_u32_u24 v10, 7168, v10
    v_add3_u32 v15, v10, v11, s49
    s_mov_b32 s32, s12
    s_mov_b32 s33, s13
    s_mov_b32 s34, 14680064
    s_mov_b32 s35, 0x20000
    s_barrier
    s_nop 0
    ds_read_b128 v[52:55], v13
    ds_read_b128 v[56:59], v13 offset:1088
    ds_read_b128 v[60:63], v13 offset:2176
    ds_read_b128 v[64:67], v13 offset:3264
    s_mov_b32 s48, 0
    s_waitcnt lgkmcnt(3)
    buffer_store_dwordx4 v[52:55], v15, s[32:35], s48 offen sc1
    s_mov_b32 s49, 28672
    s_waitcnt lgkmcnt(2)
    s_nop 0
    buffer_store_dwordx4 v[56:59], v15, s[32:35], s49 offen sc1
    s_mov_b32 s48, 57344
    s_waitcnt lgkmcnt(1)
    s_nop 0
    buffer_store_dwordx4 v[60:63], v15, s[32:35], s48 offen sc1
    s_mov_b32 s49, 86016
    s_waitcnt lgkmcnt(0)
    s_nop 0
    buffer_store_dwordx4 v[64:67], v15, s[32:35], s49 offen sc1
    s_barrier
    s_nop 0
    ds_read_b128 v[68:71], v14
    ds_read_b128 v[72:75], v14 offset:1088
    ds_read_b128 v[76:79], v14 offset:2176
    ds_read_b128 v[80:83], v14 offset:3264
    s_mov_b32 s48, 114688
    s_waitcnt lgkmcnt(3)
    s_nop 0
    buffer_store_dwordx4 v[68:71], v15, s[32:35], s48 offen sc1
    s_mov_b32 s49, 143360
    s_waitcnt lgkmcnt(2)
    s_nop 0
    buffer_store_dwordx4 v[72:75], v15, s[32:35], s49 offen sc1
    s_mov_b32 s48, 172032
    s_waitcnt lgkmcnt(1)
    s_nop 0
    buffer_store_dwordx4 v[76:79], v15, s[32:35], s48 offen sc1
    s_mov_b32 s49, 200704
    s_waitcnt lgkmcnt(0)
    s_nop 0
    buffer_store_dwordx4 v[80:83], v15, s[32:35], s49 offen sc1
    s_endpgm
    s_nop 0
L_consumer:
    s_barrier
    s_lshl_b32 s48, s44, 13
    v_and_b32 v240, 15, v0
    v_lshrrev_b32 v241, 4, v0
    v_lshrrev_b32 v242, 1, v240
    v_xor_b32 v242, v242, v241
    v_lshlrev_b32_e64 v242, 4, v242
    v_lshl_add_u32 v242, v240, 7, v242
    v_add_u32 v208, s48, v242
    v_xor_b32 v209, 64, v208
    v_and_b32 v242, 3, v240
    v_lshrrev_b32 v243, 2, v240
    v_lshl_add_u32 v242, v242, 2, v243
    v_lshlrev_b32_e64 v242, 4, v242
    v_lshl_add_u32 v242, v241, 8, v242
    v_add_u32 v212, 98304, v242
    v_xor_b32_e64 v213, 64, v212
    v_mul_u32_u24 v242, 272, v240
    v_lshl_add_u32 v242, v241, 3, v242
    v_add_u32_e64 v214, s48, v242
    s_mul_i32 s49, s44, 4352
    s_add_u32 s49, s49, 139264
    v_add_u32_e64 v216, s49, v242
    v_mul_u32_u24 v242, 208, v240
    v_lshl_add_u32 v242, v241, 3, v242
    v_add_u32_e64 v242, s48, v242
    v_add_u32 v215, 65536, v242
    v_lshrrev_b32 v240, 4, v0
    v_and_b32 v241, 15, v0
    v_mul_u32_u24 v242, 272, v240
    v_lshl_add_u32 v242, v241, 4, v242
    v_min_u32_e64 v243, 11, v241
    v_mul_u32_u24 v242, 208, v240
    v_lshl_add_u32 v242, v243, 4, v242
    v_add_u32_e64 v242, s48, v242
    v_add_u32 v217, 65536, v242
    s_lshl_b32 s49, s45, 8
    s_lshl_b32 s50, s44, 6
    s_add_u32 s49, s49, s50
    s_nop 0
    s_mul_i32 s49, s49, 7168
    s_add_u32 s49, s49, s41
    s_nop 0
    s_mul_i32 s50, s71, 229376
    s_sub_u32 s51, 229376, s50
    s_add_u32 s50, s50, s49
    s_add_u32 s51, s51, s49
    s_lshl_b32 s49, s71, 2
    v_add_u32 v242, s49, v241
    v_and_b32 v242, 15, v242
    v_lshlrev_b32 v242, 4, v242
    v_mul_u32_u24 v243, 7168, v240
    v_add3_u32 v218, v242, v243, s50
    v_add3_u32 v219, v242, v243, s51
    v_cmp_gt_u32_e64 vcc, 12, v241
    v_mov_b32 v240, 0x7f000000
    s_mov_b32 s61, 0
    s_nop 0
    s_mov_b32 s34, 14680064
    v_cndmask_b32_e64 v219, v240, v219, vcc
    s_mov_b32 s35, 0x20000
    s_mov_b32 s42, 0
    s_nop 0
    s_mov_b32 s14, 32768
    s_mov_b32 s15, 0xffff0000
    v_lshlrev_b32 v240, 4, v0
    s_lshl_b32 s49, s44, 10
    s_add_u32 s49, s49, 131072
    v_add_u32_e64 v240, s49, v240
    ds_read_b128 v[112:115], v240
    s_mov_b32 s56, 0x7fff0000
    s_lshl_b32 s49, s44, 2
    s_nop 0
    s_add_u32 s49, s49, 156672
    v_mov_b32 v241, s49
    s_waitcnt lgkmcnt(0)
    v_lshlrev_b32 v116, 16, v112
    v_and_b32 v112, s56, v112
    v_and_b32 v116, s56, v116
    v_lshlrev_b32 v117, 16, v113
    v_and_b32 v113, s56, v113
    v_and_b32 v117, s56, v117
    v_lshlrev_b32 v118, 16, v114
    v_and_b32 v114, s56, v114
    v_and_b32 v118, s56, v118
    v_lshlrev_b32 v119, 16, v115
    v_and_b32 v115, s56, v115
    v_and_b32 v119, s56, v119
    v_max3_u32 v112, v112, v113, v114
    v_max3_u32 v116, v116, v117, v118
    v_max3_u32 v112, v112, v115, v119
    v_max_u32_e64 v112, v112, v116
    v_cmp_le_u32 vcc, 0x73800000, v112
    s_nop 1
    s_or_b32 s49, vcc_lo, vcc_hi
    v_mov_b32_e64 v242, s49
    ds_write_b32 v241, v242
    v_mov_b32 v1, 0
    v_mov_b32 v2, 0
    v_mov_b32 v3, 0
    v_mov_b32 v4, 0
    v_mov_b32 v5, 0
    v_mov_b32 v6, 0
    v_mov_b32 v7, 0
    v_mov_b32 v8, 0
    v_mov_b32 v9, 0
    v_mov_b32 v10, 0
    v_mov_b32 v11, 0
    v_mov_b32 v12, 0
    v_mov_b32 v13, 0
    v_mov_b32 v14, 0
    v_mov_b32 v15, 0
    v_mov_b32 v16, 0
    v_mov_b32 v17, 0
    v_mov_b32 v18, 0
    v_mov_b32 v19, 0
    v_mov_b32 v20, 0
    v_mov_b32 v21, 0
    v_mov_b32 v22, 0
    v_mov_b32 v23, 0
    v_mov_b32 v24, 0
    v_mov_b32 v25, 0
    v_mov_b32 v26, 0
    v_mov_b32 v27, 0
    v_mov_b32 v28, 0
    v_mov_b32 v29, 0
    v_mov_b32 v30, 0
    v_mov_b32 v31, 0
    v_mov_b32 v32, 0
    v_mov_b32 v33, 0
    v_mov_b32 v34, 0
    v_mov_b32 v35, 0
    v_mov_b32 v36, 0
    v_mov_b32 v37, 0
    v_mov_b32 v38, 0
    v_mov_b32 v39, 0
    v_mov_b32 v40, 0
    v_mov_b32 v41, 0
    v_mov_b32 v42, 0
    v_mov_b32 v43, 0
    v_mov_b32 v44, 0
    v_mov_b32 v45, 0
    v_mov_b32 v46, 0
    v_mov_b32 v47, 0
    v_mov_b32 v48, 0
    v_mov_b32 v49, 0
    v_mov_b32 v50, 0
    v_mov_b32 v51, 0
    v_mov_b32 v52, 0
    v_mov_b32 v53, 0
    v_mov_b32 v54, 0
    v_mov_b32 v55, 0
    v_mov_b32 v56, 0
    v_mov_b32 v57, 0
    v_mov_b32 v58, 0
    v_mov_b32 v59, 0
    v_mov_b32 v60, 0
    v_mov_b32 v61, 0
    v_mov_b32 v62, 0
    v_mov_b32 v63, 0
    v_mov_b32 v64, 0
    v_mov_b32 v65, 0
    v_mov_b32 v66, 0
    v_mov_b32 v67, 0
    v_mov_b32 v68, 0
    v_mov_b32 v69, 0
    v_mov_b32 v70, 0
    v_mov_b32 v71, 0
    v_mov_b32 v72, 0
    v_mov_b32 v73, 0
    v_mov_b32 v74, 0
    v_mov_b32 v75, 0
    v_mov_b32 v76, 0
    v_mov_b32 v77, 0
    v_mov_b32 v78, 0
    v_mov_b32 v79, 0
    v_mov_b32 v80, 0
    v_mov_b32 v81, 0
    v_mov_b32 v82, 0
    v_mov_b32 v83, 0
    v_mov_b32 v84, 0
    v_mov_b32 v85, 0
    v_mov_b32 v86, 0
    v_mov_b32 v87, 0
    v_mov_b32 v88, 0
    v_mov_b32 v89, 0
    v_mov_b32 v90, 0
    v_mov_b32 v91, 0
    v_mov_b32 v92, 0
    v_mov_b32 v93, 0
    v_mov_b32 v94, 0
    v_mov_b32 v95, 0
    v_mov_b32 v96, 0
    v_mov_b32 v97, 0
    v_mov_b32 v98, 0
    v_mov_b32 v99, 0
    v_mov_b32 v100, 0
    v_mov_b32 v101, 0
    v_mov_b32 v102, 0
    v_mov_b32 v103, 0
    v_mov_b32 v104, 0
    v_mov_b32 v105, 0
    v_mov_b32 v106, 0
    v_mov_b32 v107, 0
    v_mov_b32 v108, 0
    v_mov_b32 v109, 0
    v_mov_b32 v110, 0
    v_mov_b32 v111, 0
    v_mov_b32 v0, 0
    s_waitcnt lgkmcnt(0)
    s_mov_b32 s32, s12
    s_mov_b32 s33, s13
    s_barrier
    ds_read_b128 v[112:115], v212 offset:0
    ds_read_b128 v[116:119], v213 offset:1024
    ds_read_b128 v[144:147], v208
    ds_read_b128 v[120:123], v212 offset:2048
    ds_read_b128 v[148:151], v208 offset:2048
    ds_read_b128 v[124:127], v213 offset:3072
    ds_read_b128 v[152:155], v208 offset:4096
    ds_read_b128 v[128:131], v212 offset:4096
    ds_read_b128 v[156:159], v208 offset:6144
    ds_read_b128 v[132:135], v213 offset:5120
    ds_read_b128 v[136:139], v212 offset:6144
    ds_read_b128 v[140:143], v213 offset:7168
    s_nop 0
    s_nop 0
    s_nop 0
    s_nop 0
    s_nop 0
    s_nop 0
L_loop:
    s_waitcnt lgkmcnt(0)
    s_nop 0
    v_mfma_f32_16x16x32_bf16 v[0:3], v[112:115], v[144:147], v[0:3]
    v_mfma_f32_16x16x32_bf16 v[32:35], v[112:115], v[148:151], v[32:35]
    v_mfma_f32_16x16x32_bf16 v[64:67], v[112:115], v[152:155], v[64:67]
    ds_read_b128 v[160:163], v212 offset:8192
    v_mfma_f32_16x16x32_bf16 v[88:91], v[112:115], v[156:159], v[88:91]
    v_mfma_f32_16x16x32_bf16 v[92:95], v[116:119], v[156:159], v[92:95]
    ds_read_b128 v[164:167], v213 offset:9216
    v_mfma_f32_16x16x32_bf16 v[68:71], v[116:119], v[152:155], v[68:71]
    v_mfma_f32_16x16x32_bf16 v[36:39], v[116:119], v[148:151], v[36:39]
    ds_read_b128 v[192:195], v209
    v_mfma_f32_16x16x32_bf16 v[4:7], v[116:119], v[144:147], v[4:7]
    v_mfma_f32_16x16x32_bf16 v[8:11], v[120:123], v[144:147], v[8:11]
    ds_read_b128 v[168:171], v212 offset:10240
    v_mfma_f32_16x16x32_bf16 v[40:43], v[120:123], v[148:151], v[40:43]
    v_mfma_f32_16x16x32_bf16 v[72:75], v[120:123], v[152:155], v[72:75]
    ds_read_b128 v[196:199], v209 offset:2048
    v_mfma_f32_16x16x32_bf16 v[96:99], v[120:123], v[156:159], v[96:99]
    v_mfma_f32_16x16x32_bf16 v[100:103], v[124:127], v[156:159], v[100:103]
    ds_read_b128 v[172:175], v213 offset:11264
    v_mfma_f32_16x16x32_bf16 v[76:79], v[124:127], v[152:155], v[76:79]
    v_mfma_f32_16x16x32_bf16 v[44:47], v[124:127], v[148:151], v[44:47]
    ds_read_b128 v[200:203], v209 offset:4096
    v_mfma_f32_16x16x32_bf16 v[12:15], v[124:127], v[144:147], v[12:15]
    v_mfma_f32_16x16x32_bf16 v[16:19], v[128:131], v[144:147], v[16:19]
    ds_read_b128 v[176:179], v212 offset:12288
    v_mfma_f32_16x16x32_bf16 v[48:51], v[128:131], v[148:151], v[48:51]
    v_mfma_f32_16x16x32_bf16 v[80:83], v[128:131], v[152:155], v[80:83]
    ds_read_b128 v[204:207], v209 offset:6144
    v_mfma_f32_16x16x32_bf16 v[104:107], v[128:131], v[156:159], v[104:107]
    v_mfma_f32_16x16x32_bf16 v[108:111], v[132:135], v[156:159], v[108:111]
    ds_read_b128 v[180:183], v213 offset:13312
    v_mfma_f32_16x16x32_bf16 v[84:87], v[132:135], v[152:155], v[84:87]
    v_mfma_f32_16x16x32_bf16 v[52:55], v[132:135], v[148:151], v[52:55]
    ds_read_b128 v[184:187], v212 offset:14336
    v_mfma_f32_16x16x32_bf16 v[20:23], v[132:135], v[144:147], v[20:23]
    v_mfma_f32_16x16x32_bf16 v[24:27], v[136:139], v[144:147], v[24:27]
    ds_read_b128 v[188:191], v213 offset:15360
    v_mfma_f32_16x16x32_bf16 v[56:59], v[136:139], v[148:151], v[56:59]
    v_mfma_f32_16x16x32_bf16 v[60:63], v[140:143], v[148:151], v[60:63]
    v_mfma_f32_16x16x32_bf16 v[28:31], v[140:143], v[144:147], v[28:31]
    s_add_u32 s42, s42, 1
    s_cmp_eq_u32 s42, 3
    s_cselect_b32 s43, s15, s14
    s_cselect_b32 s42, 0, s42
    s_waitcnt lgkmcnt(0)
    s_barrier
    v_mfma_f32_16x16x32_bf16 v[0:3], v[160:163], v[192:195], v[0:3]
    v_xor_b32 v212, 16384, v212
    v_xor_b32 v213, 16384, v213
    v_add_u32_e64 v208, s43, v208
    v_mfma_f32_16x16x32_bf16 v[32:35], v[160:163], v[196:199], v[32:35]
    v_mfma_f32_16x16x32_bf16 v[64:67], v[160:163], v[200:203], v[64:67]
    v_mfma_f32_16x16x32_bf16 v[88:91], v[160:163], v[204:207], v[88:91]
    ds_read_b128 v[112:115], v212 offset:0
    v_mfma_f32_16x16x32_bf16 v[92:95], v[164:167], v[204:207], v[92:95]
    v_mfma_f32_16x16x32_bf16 v[68:71], v[164:167], v[200:203], v[68:71]
    ds_read_b128 v[116:119], v213 offset:1024
    v_mfma_f32_16x16x32_bf16 v[36:39], v[164:167], v[196:199], v[36:39]
    v_mfma_f32_16x16x32_bf16 v[4:7], v[164:167], v[192:195], v[4:7]
    ds_read_b128 v[144:147], v208
    v_mfma_f32_16x16x32_bf16 v[8:11], v[168:171], v[192:195], v[8:11]
    v_mfma_f32_16x16x32_bf16 v[40:43], v[168:171], v[196:199], v[40:43]
    ds_read_b128 v[120:123], v212 offset:2048
    v_mfma_f32_16x16x32_bf16 v[72:75], v[168:171], v[200:203], v[72:75]
    v_mfma_f32_16x16x32_bf16 v[96:99], v[168:171], v[204:207], v[96:99]
    ds_read_b128 v[148:151], v208 offset:2048
    v_mfma_f32_16x16x32_bf16 v[100:103], v[172:175], v[204:207], v[100:103]
    v_mfma_f32_16x16x32_bf16 v[76:79], v[172:175], v[200:203], v[76:79]
    ds_read_b128 v[124:127], v213 offset:3072
    v_mfma_f32_16x16x32_bf16 v[44:47], v[172:175], v[196:199], v[44:47]
    v_mfma_f32_16x16x32_bf16 v[12:15], v[172:175], v[192:195], v[12:15]
    ds_read_b128 v[152:155], v208 offset:4096
    v_mfma_f32_16x16x32_bf16 v[16:19], v[176:179], v[192:195], v[16:19]
    v_mfma_f32_16x16x32_bf16 v[48:51], v[176:179], v[196:199], v[48:51]
    ds_read_b128 v[128:131], v212 offset:4096
    v_mfma_f32_16x16x32_bf16 v[80:83], v[176:179], v[200:203], v[80:83]
    v_mfma_f32_16x16x32_bf16 v[104:107], v[176:179], v[204:207], v[104:107]
    ds_read_b128 v[156:159], v208 offset:6144
    v_mfma_f32_16x16x32_bf16 v[108:111], v[180:183], v[204:207], v[108:111]
    v_mfma_f32_16x16x32_bf16 v[84:87], v[180:183], v[200:203], v[84:87]
    ds_read_b128 v[132:135], v213 offset:5120
    v_mfma_f32_16x16x32_bf16 v[52:55], v[180:183], v[196:199], v[52:55]
    v_mfma_f32_16x16x32_bf16 v[20:23], v[180:183], v[192:195], v[20:23]
    ds_read_b128 v[136:139], v212 offset:6144
    v_mfma_f32_16x16x32_bf16 v[24:27], v[184:187], v[192:195], v[24:27]
    v_mfma_f32_16x16x32_bf16 v[56:59], v[184:187], v[196:199], v[56:59]
    ds_read_b128 v[140:143], v213 offset:7168
    v_mfma_f32_16x16x32_bf16 v[60:63], v[188:191], v[196:199], v[60:63]
    v_add_u32_e64 v209, s43, v209
    v_mfma_f32_16x16x32_bf16 v[28:31], v[188:191], v[192:195], v[28:31]
    s_add_u32 s61, s61, 1
    s_cmp_lt_u32 s61, 14
    s_cbranch_scc1 L_loop
    s_waitcnt lgkmcnt(9)
    v_mfma_f32_16x16x32_bf16 v[0:3], v[112:115], v[144:147], v[0:3]
    ds_read_b128 v[160:163], v212 offset:8192
    s_waitcnt lgkmcnt(8)
    s_nop 0
    v_mfma_f32_16x16x32_bf16 v[32:35], v[112:115], v[148:151], v[32:35]
    ds_read_b128 v[192:195], v209
    v_mfma_f32_16x16x32_bf16 v[36:39], v[116:119], v[148:151], v[36:39]
    ds_read_b128 v[164:167], v213 offset:9216
    v_mfma_f32_16x16x32_bf16 v[4:7], v[116:119], v[144:147], v[4:7]
    ds_read_b128 v[196:199], v209 offset:2048
    v_mfma_f32_16x16x32_bf16 v[8:11], v[120:123], v[144:147], v[8:11]
    ds_read_b128 v[168:171], v212 offset:10240
    v_mfma_f32_16x16x32_bf16 v[40:43], v[120:123], v[148:151], v[40:43]
    ds_read_b128 v[172:175], v213 offset:11264
    s_waitcnt lgkmcnt(12)
    s_nop 0
    v_mfma_f32_16x16x32_bf16 v[44:47], v[124:127], v[148:151], v[44:47]
    ds_read_b128 v[176:179], v212 offset:12288
    v_mfma_f32_16x16x32_bf16 v[12:15], v[124:127], v[144:147], v[12:15]
    ds_read_b128 v[180:183], v213 offset:13312
    s_waitcnt lgkmcnt(12)
    s_nop 0
    v_mfma_f32_16x16x32_bf16 v[16:19], v[128:131], v[144:147], v[16:19]
    ds_read_b128 v[184:187], v212 offset:14336
    v_mfma_f32_16x16x32_bf16 v[48:51], v[128:131], v[148:151], v[48:51]
    ds_read_b128 v[188:191], v213 offset:15360
    s_waitcnt lgkmcnt(12)
    s_nop 0
    v_mfma_f32_16x16x32_bf16 v[52:55], v[132:135], v[148:151], v[52:55]
    v_add_u32 v220, s15, v208
    v_add_u32 v221, s15, v209
    v_mfma_f32_16x16x32_bf16 v[20:23], v[132:135], v[144:147], v[20:23]
    v_xor_b32 v222, 16384, v212
    v_xor_b32 v223, 16384, v213
    s_waitcnt lgkmcnt(11)
    s_nop 0
    v_mfma_f32_16x16x32_bf16 v[24:27], v[136:139], v[144:147], v[24:27]
    v_mfma_f32_16x16x32_bf16 v[56:59], v[136:139], v[148:151], v[56:59]
    s_waitcnt lgkmcnt(10)
    s_nop 0
    v_mfma_f32_16x16x32_bf16 v[60:63], v[140:143], v[148:151], v[60:63]
    v_mfma_f32_16x16x32_bf16 v[28:31], v[140:143], v[144:147], v[28:31]
    s_barrier
    s_nop 0
    v_mbcnt_lo_u32_b32 v240, -1, 0
    v_and_b32 v240, 7, v240
    v_lshlrev_b32 v240, 2, v240
    v_add_u32 v240, 0x20000, v240
    ds_read_b32 v240, v240 offset:25600
    s_waitcnt lgkmcnt(9)
    s_nop 0
    v_mfma_f32_16x16x32_bf16 v[0:3], v[160:163], v[192:195], v[0:3]
    ds_read_b128 v[112:115], v222 offset:0
    s_waitcnt lgkmcnt(8)
    s_nop 0
    v_mfma_f32_16x16x32_bf16 v[32:35], v[160:163], v[196:199], v[32:35]
    ds_read_b128 v[144:147], v220
    v_mfma_f32_16x16x32_bf16 v[36:39], v[164:167], v[196:199], v[36:39]
    ds_read_b128 v[116:119], v223 offset:1024
    v_mfma_f32_16x16x32_bf16 v[4:7], v[164:167], v[192:195], v[4:7]
    ds_read_b128 v[148:151], v220 offset:2048
    s_waitcnt lgkmcnt(10)
    s_nop 0
    v_mfma_f32_16x16x32_bf16 v[8:11], v[168:171], v[192:195], v[8:11]
    ds_read_b128 v[120:123], v222 offset:2048
    v_mfma_f32_16x16x32_bf16 v[40:43], v[168:171], v[196:199], v[40:43]
    ds_read_b128 v[124:127], v223 offset:3072
    s_waitcnt lgkmcnt(11)
    s_nop 0
    v_mfma_f32_16x16x32_bf16 v[44:47], v[172:175], v[196:199], v[44:47]
    ds_read_b128 v[128:131], v222 offset:4096
    v_mfma_f32_16x16x32_bf16 v[12:15], v[172:175], v[192:195], v[12:15]
    ds_read_b128 v[132:135], v223 offset:5120
    s_waitcnt lgkmcnt(12)
    s_nop 0
    v_mfma_f32_16x16x32_bf16 v[16:19], v[176:179], v[192:195], v[16:19]
    ds_read_b128 v[136:139], v222 offset:6144
    v_mfma_f32_16x16x32_bf16 v[48:51], v[176:179], v[196:199], v[48:51]
    ds_read_b128 v[140:143], v223 offset:7168
    s_waitcnt lgkmcnt(13)
    s_nop 0
    v_mfma_f32_16x16x32_bf16 v[52:55], v[180:183], v[196:199], v[52:55]
    v_mfma_f32_16x16x32_bf16 v[20:23], v[180:183], v[192:195], v[20:23]
    s_waitcnt lgkmcnt(12)
    s_nop 0
    v_mfma_f32_16x16x32_bf16 v[24:27], v[184:187], v[192:195], v[24:27]
    v_mfma_f32_16x16x32_bf16 v[56:59], v[184:187], v[196:199], v[56:59]
    s_waitcnt lgkmcnt(11)
    s_nop 0
    v_mfma_f32_16x16x32_bf16 v[60:63], v[188:191], v[196:199], v[60:63]
    v_mfma_f32_16x16x32_bf16 v[28:31], v[188:191], v[192:195], v[28:31]
    s_waitcnt lgkmcnt(10)
    v_cmp_ne_u32 vcc, 0, v240
    s_nop 4
    s_cbranch_vccnz L_fallback
    s_waitcnt lgkmcnt(8)
    s_nop 0
    v_mfma_f32_16x16x32_bf16 v[0:3], v[112:115], v[144:147], v[0:3]
    ds_read_b128 v[160:163], v222 offset:8192
    s_waitcnt lgkmcnt(7)
    s_nop 0
    v_mfma_f32_16x16x32_bf16 v[32:35], v[112:115], v[148:151], v[32:35]
    ds_read_b128 v[192:195], v221
    v_mfma_f32_16x16x32_bf16 v[36:39], v[116:119], v[148:151], v[36:39]
    ds_read_b128 v[164:167], v223 offset:9216
    v_mfma_f32_16x16x32_bf16 v[4:7], v[116:119], v[144:147], v[4:7]
    ds_read_b128 v[196:199], v221 offset:2048
    s_waitcnt lgkmcnt(9)
    s_nop 0
    v_mfma_f32_16x16x32_bf16 v[8:11], v[120:123], v[144:147], v[8:11]
    ds_read_b128 v[168:171], v222 offset:10240
    v_mfma_f32_16x16x32_bf16 v[40:43], v[120:123], v[148:151], v[40:43]
    ds_read_b128 v[172:175], v223 offset:11264
    s_waitcnt lgkmcnt(10)
    s_nop 0
    v_mfma_f32_16x16x32_bf16 v[44:47], v[124:127], v[148:151], v[44:47]
    ds_read_b128 v[176:179], v222 offset:12288
    v_mfma_f32_16x16x32_bf16 v[12:15], v[124:127], v[144:147], v[12:15]
    ds_read_b128 v[180:183], v223 offset:13312
    s_waitcnt lgkmcnt(11)
    s_nop 0
    v_mfma_f32_16x16x32_bf16 v[16:19], v[128:131], v[144:147], v[16:19]
    ds_read_b128 v[184:187], v222 offset:14336
    v_mfma_f32_16x16x32_bf16 v[48:51], v[128:131], v[148:151], v[48:51]
    ds_read_b128 v[188:191], v223 offset:15360
    s_waitcnt lgkmcnt(12)
    s_nop 0
    v_mfma_f32_16x16x32_bf16 v[52:55], v[132:135], v[148:151], v[52:55]
    v_mfma_f32_16x16x32_bf16 v[20:23], v[132:135], v[144:147], v[20:23]
    s_waitcnt lgkmcnt(11)
    s_nop 0
    v_mfma_f32_16x16x32_bf16 v[24:27], v[136:139], v[144:147], v[24:27]
    v_mfma_f32_16x16x32_bf16 v[56:59], v[136:139], v[148:151], v[56:59]
    s_waitcnt lgkmcnt(10)
    s_nop 0
    v_mfma_f32_16x16x32_bf16 v[60:63], v[140:143], v[148:151], v[60:63]
    v_mfma_f32_16x16x32_bf16 v[28:31], v[140:143], v[144:147], v[28:31]
    s_waitcnt lgkmcnt(8)
    s_nop 0
    v_mfma_f32_16x16x32_bf16 v[0:3], v[160:163], v[192:195], v[0:3]
    ds_read_b128 v[112:115], v212 offset:0
    s_waitcnt lgkmcnt(8)
    s_nop 0
    v_mfma_f32_16x16x32_bf16 v[4:7], v[164:167], v[192:195], v[4:7]
    ds_read_b128 v[152:155], v208 offset:4096
    s_waitcnt lgkmcnt(7)
    s_nop 0
    v_mfma_f32_16x16x32_bf16 v[8:11], v[168:171], v[192:195], v[8:11]
    ds_read_b128 v[116:119], v213 offset:1024
    s_waitcnt lgkmcnt(7)
    s_nop 0
    v_mfma_f32_16x16x32_bf16 v[12:15], v[172:175], v[192:195], v[12:15]
    ds_read_b128 v[156:159], v208 offset:6144
    s_waitcnt lgkmcnt(7)
    s_nop 0
    v_mfma_f32_16x16x32_bf16 v[16:19], v[176:179], v[192:195], v[16:19]
    ds_read_b128 v[120:123], v212 offset:2048
    s_waitcnt lgkmcnt(7)
    s_nop 0
    v_mfma_f32_16x16x32_bf16 v[20:23], v[180:183], v[192:195], v[20:23]
    ds_read_b128 v[124:127], v213 offset:3072
    s_waitcnt lgkmcnt(7)
    s_nop 0
    v_mfma_f32_16x16x32_bf16 v[24:27], v[184:187], v[192:195], v[24:27]
    ds_read_b128 v[128:131], v212 offset:4096
    s_waitcnt lgkmcnt(7)
    s_nop 0
    v_mfma_f32_16x16x32_bf16 v[28:31], v[188:191], v[192:195], v[28:31]
    ds_read_b128 v[132:135], v213 offset:5120
    v_mfma_f32_16x16x32_bf16 v[32:35], v[160:163], v[196:199], v[32:35]
    v_cvt_pk_bf16_f32 v224, v0, v1
    v_cvt_pk_bf16_f32 v225, v2, v3
    ds_write_b64 v214, v[224:225] offset:32768
    v_mfma_f32_16x16x32_bf16 v[36:39], v[164:167], v[196:199], v[36:39]
    v_cvt_pk_bf16_f32 v226, v4, v5
    v_cvt_pk_bf16_f32 v227, v6, v7
    ds_write_b64 v214, v[226:227] offset:32800
    v_mfma_f32_16x16x32_bf16 v[40:43], v[168:171], v[196:199], v[40:43]
    v_cvt_pk_bf16_f32 v228, v8, v9
    v_cvt_pk_bf16_f32 v229, v10, v11
    ds_write_b64 v214, v[228:229] offset:32832
    v_mfma_f32_16x16x32_bf16 v[44:47], v[172:175], v[196:199], v[44:47]
    v_cvt_pk_bf16_f32 v230, v12, v13
    v_cvt_pk_bf16_f32 v231, v14, v15
    ds_write_b64 v214, v[230:231] offset:32864
    v_mfma_f32_16x16x32_bf16 v[48:51], v[176:179], v[196:199], v[48:51]
    v_cvt_pk_bf16_f32 v232, v16, v17
    v_cvt_pk_bf16_f32 v233, v18, v19
    ds_write_b64 v214, v[232:233] offset:32896
    v_mfma_f32_16x16x32_bf16 v[52:55], v[180:183], v[196:199], v[52:55]
    v_cvt_pk_bf16_f32 v234, v20, v21
    v_cvt_pk_bf16_f32 v235, v22, v23
    ds_write_b64 v214, v[234:235] offset:32928
    v_mfma_f32_16x16x32_bf16 v[56:59], v[184:187], v[196:199], v[56:59]
    v_cvt_pk_bf16_f32 v236, v24, v25
    v_cvt_pk_bf16_f32 v237, v26, v27
    ds_write_b64 v214, v[236:237] offset:32960
    v_mfma_f32_16x16x32_bf16 v[60:63], v[188:191], v[196:199], v[60:63]
    v_cvt_pk_bf16_f32 v238, v28, v29
    v_cvt_pk_bf16_f32 v239, v30, v31
    ds_write_b64 v214, v[238:239] offset:32992
    s_waitcnt lgkmcnt(0)
    s_barrier
    v_mfma_f32_16x16x32_bf16 v[64:67], v[112:115], v[152:155], v[64:67]
    ds_read_b128 v[160:163], v212 offset:8192
    v_cvt_pk_bf16_f32 v224, v32, v33
    v_cvt_pk_bf16_f32 v225, v34, v35
    ds_write_b64 v216, v[224:225]
    v_mfma_f32_16x16x32_bf16 v[88:91], v[112:115], v[156:159], v[88:91]
    ds_read_b128 v[200:203], v209 offset:4096
    v_cvt_pk_bf16_f32 v226, v36, v37
    v_cvt_pk_bf16_f32 v227, v38, v39
    ds_write_b64 v216, v[226:227] offset:32
    v_mfma_f32_16x16x32_bf16 v[92:95], v[116:119], v[156:159], v[92:95]
    ds_read_b128 v[164:167], v213 offset:9216
    v_cvt_pk_bf16_f32 v228, v40, v41
    v_cvt_pk_bf16_f32 v229, v42, v43
    ds_write_b64 v216, v[228:229] offset:64
    v_mfma_f32_16x16x32_bf16 v[68:71], v[116:119], v[152:155], v[68:71]
    ds_read_b128 v[204:207], v209 offset:6144
    v_cvt_pk_bf16_f32 v230, v44, v45
    v_cvt_pk_bf16_f32 v231, v46, v47
    ds_write_b64 v216, v[230:231] offset:96
    v_mfma_f32_16x16x32_bf16 v[72:75], v[120:123], v[152:155], v[72:75]
    ds_read_b128 v[168:171], v212 offset:10240
    v_cvt_pk_bf16_f32 v232, v48, v49
    v_cvt_pk_bf16_f32 v233, v50, v51
    ds_write_b64 v216, v[232:233] offset:128
    v_mfma_f32_16x16x32_bf16 v[96:99], v[120:123], v[156:159], v[96:99]
    ds_read_b128 v[172:175], v213 offset:11264
    v_cvt_pk_bf16_f32 v234, v52, v53
    v_cvt_pk_bf16_f32 v235, v54, v55
    ds_write_b64 v216, v[234:235] offset:160
    v_mfma_f32_16x16x32_bf16 v[100:103], v[124:127], v[156:159], v[100:103]
    ds_read_b128 v[176:179], v212 offset:12288
    v_cvt_pk_bf16_f32 v236, v56, v57
    v_cvt_pk_bf16_f32 v237, v58, v59
    ds_write_b64 v216, v[236:237] offset:192
    v_mfma_f32_16x16x32_bf16 v[76:79], v[124:127], v[152:155], v[76:79]
    ds_read_b128 v[180:183], v213 offset:13312
    v_cvt_pk_bf16_f32 v238, v60, v61
    v_cvt_pk_bf16_f32 v239, v62, v63
    ds_write_b64 v216, v[238:239] offset:224
    v_mfma_f32_16x16x32_bf16 v[80:83], v[128:131], v[152:155], v[80:83]
    v_mfma_f32_16x16x32_bf16 v[104:107], v[128:131], v[156:159], v[104:107]
    v_mfma_f32_16x16x32_bf16 v[108:111], v[132:135], v[156:159], v[108:111]
    v_mfma_f32_16x16x32_bf16 v[84:87], v[132:135], v[152:155], v[84:87]
    s_waitcnt lgkmcnt(0)
    s_barrier
    v_mfma_f32_16x16x32_bf16 v[64:67], v[160:163], v[200:203], v[64:67]
    ds_read_b128 v[112:115], v222 offset:0
    v_mfma_f32_16x16x32_bf16 v[88:91], v[160:163], v[204:207], v[88:91]
    ds_read_b128 v[152:155], v220 offset:4096
    v_mfma_f32_16x16x32_bf16 v[92:95], v[164:167], v[204:207], v[92:95]
    ds_read_b128 v[116:119], v223 offset:1024
    v_mfma_f32_16x16x32_bf16 v[68:71], v[164:167], v[200:203], v[68:71]
    ds_read_b128 v[156:159], v220 offset:6144
    v_mfma_f32_16x16x32_bf16 v[72:75], v[168:171], v[200:203], v[72:75]
    ds_read_b128 v[120:123], v222 offset:2048
    v_mfma_f32_16x16x32_bf16 v[96:99], v[168:171], v[204:207], v[96:99]
    ds_read_b128 v[124:127], v223 offset:3072
    v_mfma_f32_16x16x32_bf16 v[100:103], v[172:175], v[204:207], v[100:103]
    ds_read_b128 v[128:131], v222 offset:4096
    v_mfma_f32_16x16x32_bf16 v[76:79], v[172:175], v[200:203], v[76:79]
    ds_read_b128 v[132:135], v223 offset:5120
    v_mfma_f32_16x16x32_bf16 v[80:83], v[176:179], v[200:203], v[80:83]
    v_mfma_f32_16x16x32_bf16 v[104:107], v[176:179], v[204:207], v[104:107]
    v_mfma_f32_16x16x32_bf16 v[108:111], v[180:183], v[204:207], v[108:111]
    v_mfma_f32_16x16x32_bf16 v[84:87], v[180:183], v[200:203], v[84:87]
    s_waitcnt lgkmcnt(6)
    s_nop 0
    v_mfma_f32_16x16x32_bf16 v[64:67], v[112:115], v[152:155], v[64:67]
    ds_read_b128 v[160:163], v222 offset:8192
    s_waitcnt lgkmcnt(5)
    s_nop 0
    v_mfma_f32_16x16x32_bf16 v[88:91], v[112:115], v[156:159], v[88:91]
    ds_read_b128 v[200:203], v221 offset:4096
    v_mfma_f32_16x16x32_bf16 v[92:95], v[116:119], v[156:159], v[92:95]
    ds_read_b128 v[164:167], v223 offset:9216
    v_mfma_f32_16x16x32_bf16 v[68:71], v[116:119], v[152:155], v[68:71]
    ds_read_b128 v[204:207], v221 offset:6144
    s_waitcnt lgkmcnt(7)
    s_nop 0
    v_mfma_f32_16x16x32_bf16 v[72:75], v[120:123], v[152:155], v[72:75]
    ds_read_b128 v[168:171], v222 offset:10240
    v_mfma_f32_16x16x32_bf16 v[96:99], v[120:123], v[156:159], v[96:99]
    ds_read_b128 v[172:175], v223 offset:11264
    s_waitcnt lgkmcnt(8)
    s_nop 0
    v_mfma_f32_16x16x32_bf16 v[100:103], v[124:127], v[156:159], v[100:103]
    ds_read_b128 v[176:179], v222 offset:12288
    v_mfma_f32_16x16x32_bf16 v[76:79], v[124:127], v[152:155], v[76:79]
    ds_read_b128 v[180:183], v223 offset:13312
    s_waitcnt lgkmcnt(9)
    s_nop 0
    v_mfma_f32_16x16x32_bf16 v[80:83], v[128:131], v[152:155], v[80:83]
    v_mfma_f32_16x16x32_bf16 v[104:107], v[128:131], v[156:159], v[104:107]
    s_waitcnt lgkmcnt(8)
    s_nop 0
    v_mfma_f32_16x16x32_bf16 v[108:111], v[132:135], v[156:159], v[108:111]
    v_mfma_f32_16x16x32_bf16 v[84:87], v[132:135], v[152:155], v[84:87]
    s_waitcnt lgkmcnt(6)
    s_nop 0
    v_mfma_f32_16x16x32_bf16 v[64:67], v[160:163], v[200:203], v[64:67]
    s_waitcnt lgkmcnt(5)
    s_nop 0
    v_mfma_f32_16x16x32_bf16 v[68:71], v[164:167], v[200:203], v[68:71]
    s_waitcnt lgkmcnt(3)
    s_nop 0
    v_mfma_f32_16x16x32_bf16 v[72:75], v[168:171], v[200:203], v[72:75]
    s_waitcnt lgkmcnt(2)
    s_nop 0
    v_mfma_f32_16x16x32_bf16 v[76:79], v[172:175], v[200:203], v[76:79]
    s_waitcnt lgkmcnt(1)
    s_nop 0
    v_mfma_f32_16x16x32_bf16 v[80:83], v[176:179], v[200:203], v[80:83]
    s_waitcnt lgkmcnt(0)
    s_nop 0
    v_mfma_f32_16x16x32_bf16 v[84:87], v[180:183], v[200:203], v[84:87]
    v_mfma_f32_16x16x32_bf16 v[88:91], v[160:163], v[204:207], v[88:91]
    v_mfma_f32_16x16x32_bf16 v[92:95], v[164:167], v[204:207], v[92:95]
    v_mfma_f32_16x16x32_bf16 v[96:99], v[168:171], v[204:207], v[96:99]
    v_cvt_pk_bf16_f32 v224, v64, v65
    v_cvt_pk_bf16_f32 v225, v66, v67
    ds_write_b64 v215, v[224:225]
    v_mfma_f32_16x16x32_bf16 v[100:103], v[172:175], v[204:207], v[100:103]
    v_cvt_pk_bf16_f32 v226, v68, v69
    v_cvt_pk_bf16_f32 v227, v70, v71
    ds_write_b64 v215, v[226:227] offset:32
    v_mfma_f32_16x16x32_bf16 v[104:107], v[176:179], v[204:207], v[104:107]
    v_cvt_pk_bf16_f32 v228, v72, v73
    v_cvt_pk_bf16_f32 v229, v74, v75
    ds_write_b64 v215, v[228:229] offset:64
    v_mfma_f32_16x16x32_bf16 v[108:111], v[180:183], v[204:207], v[108:111]
    v_cvt_pk_bf16_f32 v230, v76, v77
    v_cvt_pk_bf16_f32 v231, v78, v79
    ds_write_b64 v215, v[230:231] offset:96
    v_cvt_pk_bf16_f32 v232, v80, v81
    v_cvt_pk_bf16_f32 v233, v82, v83
    ds_write_b64 v215, v[232:233] offset:128
    v_cvt_pk_bf16_f32 v234, v84, v85
    v_cvt_pk_bf16_f32 v235, v86, v87
    ds_write_b64 v215, v[234:235] offset:160
    ds_read_b128 v[0:3], v217
    ds_read_b128 v[4:7], v217 offset:832
    ds_read_b128 v[8:11], v217 offset:1664
    ds_read_b128 v[12:15], v217 offset:2496
    v_cvt_pk_bf16_f32 v236, v88, v89
    v_cvt_pk_bf16_f32 v237, v90, v91
    ds_write_b64 v215, v[236:237] offset:3328
    v_cvt_pk_bf16_f32 v238, v92, v93
    v_cvt_pk_bf16_f32 v239, v94, v95
    ds_write_b64 v215, v[238:239] offset:3360
    v_cvt_pk_bf16_f32 v224, v96, v97
    v_cvt_pk_bf16_f32 v225, v98, v99
    ds_write_b64 v215, v[224:225] offset:3392
    s_waitcnt lgkmcnt(6)
    s_mov_b32 s48, 0
    buffer_store_dwordx4 v[0:3], v219, s[32:35], s48 offen sc1
    v_cvt_pk_bf16_f32 v226, v100, v101
    v_cvt_pk_bf16_f32 v227, v102, v103
    ds_write_b64 v215, v[226:227] offset:3424
    s_waitcnt lgkmcnt(6)
    s_nop 0
    s_mov_b32 s49, 28672
    buffer_store_dwordx4 v[4:7], v219, s[32:35], s49 offen sc1
    v_cvt_pk_bf16_f32 v228, v104, v105
    v_cvt_pk_bf16_f32 v229, v106, v107
    ds_write_b64 v215, v[228:229] offset:3456
    s_waitcnt lgkmcnt(6)
    s_nop 0
    s_mov_b32 s48, 57344
    buffer_store_dwordx4 v[8:11], v219, s[32:35], s48 offen sc1
    v_cvt_pk_bf16_f32 v230, v108, v109
    v_cvt_pk_bf16_f32 v231, v110, v111
    ds_write_b64 v215, v[230:231] offset:3488
    s_waitcnt lgkmcnt(6)
    s_nop 0
    s_mov_b32 s49, 86016
    buffer_store_dwordx4 v[12:15], v219, s[32:35], s49 offen sc1
    ds_read_b128 v[16:19], v217 offset:3328
    ds_read_b128 v[20:23], v217 offset:4160
    ds_read_b128 v[24:27], v217 offset:4992
    ds_read_b128 v[28:31], v217 offset:5824
    s_waitcnt lgkmcnt(3)
    s_nop 0
    s_mov_b32 s48, 114688
    buffer_store_dwordx4 v[16:19], v219, s[32:35], s48 offen sc1
    s_waitcnt lgkmcnt(2)
    s_nop 0
    s_mov_b32 s49, 143360
    buffer_store_dwordx4 v[20:23], v219, s[32:35], s49 offen sc1
    s_waitcnt lgkmcnt(1)
    s_nop 0
    s_mov_b32 s48, 172032
    buffer_store_dwordx4 v[24:27], v219, s[32:35], s48 offen sc1
    s_waitcnt lgkmcnt(0)
    s_nop 0
    s_mov_b32 s49, 200704
    buffer_store_dwordx4 v[28:31], v219, s[32:35], s49 offen sc1
L_end:
    s_endpgm
    s_nop 0
L_fallback:
    s_waitcnt vmcnt(0) lgkmcnt(0)
    s_setprio 0
    v_mbcnt_lo_u32_b32 v0, -1, 0
    v_mbcnt_hi_u32_b32 v0, -1, v0
    s_lshl_b32 s48, s44, 6
    v_add_u32 v0, s48, v0
    s_barrier
    s_nop 0
    s_nop 0
    s_nop 0
    s_nop 0
    s_nop 0
    s_nop 0
    s_nop 0
    s_nop 0
    s_nop 0
    s_nop 0
    s_nop 0
G_entry:
    s_load_dwordx4 s[4:7], s[0:1], 0
    s_load_dwordx4 s[8:11], s[0:1], 16
    s_load_dwordx2 s[12:13], s[0:1], 32
    s_cmp_ge_u32 s2, 256
    s_cbranch_scc1 G_end
    s_getpc_b64 s[36:37]
G_pc:
    s_and_b32 s48, s2, 0x78
    v_lshrrev_b32_e64 v1, 6, v0
    s_mov_b32 s38, G_end-G_pc
    v_add_u32_e64 v2, s48, v1
    s_mov_b32 s39, 0x20000
    v_lshlrev_b32 v2, 7, v2
    s_mov_b64 exec, 1
    buffer_load_dword v248, v2, s[36:39], 0 offen
    s_mov_b64 exec, -1
    v_and_b32 v0, 63, v0
    s_and_b32 s48, s2, 7
    v_readfirstlane_b32 s44, v1
    s_lshr_b32 s49, s2, 3
    s_and_b32 s50, s48, 1
    s_lshl_b32 s50, s50, 2
    s_and_b32 s45, s49, 3
    s_add_u32 s45, s45, s50
    s_lshr_b32 s50, s48, 1
    s_lshl_b32 s50, s50, 3
    s_lshr_b32 s46, s49, 2
    s_add_u32 s46, s46, s50
    s_and_b32 s71, s46, 1
    s_lshr_b32 s48, s46, 1
    s_nop 0
    s_mul_i32 s41, s48, 448
    s_mul_i32 s48, s71, 192
    s_add_u32 s41, s41, s48
    s_lshl_b32 s40, s71, 16
    s_and_b32 s47, s44, 3
    s_cmp_lt_u32 s44, 4
    s_cbranch_scc1 G_consumer
    s_setprio 1
    s_add_u32 s51, s45, s46
    s_and_b32 s51, s51, 3
    s_and_b32 s50, s46, 4
    s_or_b32 s51, s51, s50
    s_lshl_b32 s51, s51, 2
    s_nop 0
    s_lshr_b32 s60, 0x100210, s51
    s_and_b32 s60, s60, 15
    v_lshrrev_b32 v10, 4, v0
    v_and_b32_e64 v11, 15, v0
    v_mul_u32_u24 v10, 7168, v10
    v_lshl_add_u32 v1, v11, 4, v10
    s_mul_i32 s48, s47, 28672
    s_add_u32 s48, s48, s41
    s_lshl_b32 s50, s47, 10
    s_add_u32 s50, s50, 131072
    s_mov_b32 s26, 114688
    s_mov_b32 s27, 0x20000
    s_mov_b32 s22, 14680064
    s_mov_b32 s30, s26
    s_mov_b32 s31, s27
    s_mov_b32 s23, s27
    v_lshrrev_b32 v10, 5, v0
    v_and_b32 v11, 31, v0
    s_lshl_b32 s51, s47, 1
    v_add_u32_e64 v12, s51, v10
    v_mul_u32_u24 v13, 114688, v12
    s_lshl_b32 s49, s41, 1
    s_nop 0
    v_lshl_add_u32 v13, v11, 4, v13
    v_add_u32_e64 v44, s49, v13
    s_mul_i32 s54, s60, 917504
    s_mov_b32 m0, s50
    s_waitcnt lgkmcnt(0)
    s_mov_b32 s24, s8
    s_mov_b32 s25, s9
    s_mov_b32 s28, s10
    s_mov_b32 s29, s11
    buffer_load_dwordx4 v1, s[24:27], s48 offen lds
    s_add_u32 m0, s50, 4096
    s_mov_b32 s20, s6
    s_mov_b32 s21, s7
    buffer_load_dwordx4 v1, s[28:31], s48 offen lds
    buffer_load_dwordx4 v[52:55], v44, s[20:23], s54 offen
    v_add_u32 v45, 14336, v44
    buffer_load_dwordx4 v[56:59], v45, s[20:23], s54 offen
    v_add_u32 v46, 28672, v44
    buffer_load_dwordx4 v[60:63], v46, s[20:23], s54 offen
    v_add_u32 v47, 43008, v44
    buffer_load_dwordx4 v[64:67], v47, s[20:23], s54 offen
    v_add_u32 v48, 57344, v44
    buffer_load_dwordx4 v[68:71], v48, s[20:23], s54 offen
    v_add_u32 v49, 71680, v44
    buffer_load_dwordx4 v[72:75], v49, s[20:23], s54 offen
    v_add_u32 v50, 86016, v44
    buffer_load_dwordx4 v[76:79], v50, s[20:23], s54 offen
    v_add_u32 v51, 100352, v44
    buffer_load_dwordx4 v[80:83], v51, s[20:23], s54 offen
    s_mov_b32 s16, s4
    s_mov_b32 s17, s5
    s_mov_b32 s18, 4194304
    s_mov_b32 s19, s27
    s_add_u32 s51, s45, s46
    s_and_b32 s51, s51, 3
    s_and_b32 s50, s46, 4
    s_or_b32 s51, s51, s50
    s_nop 0
    s_mov_b32 s58, 0x68532410
    s_mov_b32 s59, 0xfedbca97
    s_cmp_eq_u32 s51, 1
    s_nop 0
    s_cmov_b32 s58, 0x76435201
    s_cmov_b32 s59, 0xfecdba89
    s_cmp_eq_u32 s51, 2
    s_nop 0
    s_cmov_b32 s58, 0x75463102
    s_cmov_b32 s59, 0xfdecb9a8
    s_cmp_eq_u32 s51, 3
    s_nop 0
    s_cmov_b32 s58, 0x65742130
    s_cmov_b32 s59, 0xefdcab98
    s_cmp_eq_u32 s51, 4
    s_nop 0
    s_cmov_b32 s58, 0x86534210
    s_cmov_b32 s59, 0xfedbac97
    s_cmp_eq_u32 s51, 5
    s_nop 0
    s_cmov_b32 s58, 0x96453201
    s_cmov_b32 s59, 0xfecbda87
    s_cmp_eq_u32 s51, 6
    s_nop 0
    s_cmov_b32 s58, 0x75643120
    s_cmov_b32 s59, 0xfdceb98a
    s_cmp_eq_u32 s51, 7
    s_nop 0
    s_cmov_b32 s58, 0x67542310
    s_cmov_b32 s59, 0xedfca9b8
    s_lshr_b64 s[58:59], s[58:59], 4
    s_lshl_b32 s51, s47, 1
    s_lshl_b32 s69, s60, 8
    s_lshl_b32 s68, s60, 7
    s_or_b32 s68, s68, s40
    s_lshl_b32 s48, s45, 8
    s_lshl_b32 s49, s47, 6
    s_add_u32 s48, s48, s49
    s_lshl_b32 s48, s48, 11
    s_lshl_b32 s70, s47, 13
    v_lshrrev_b32 v10, 3, v0
    v_lshlrev_b32 v10, 11, v10
    v_add_u32 v10, s48, v10
    v_and_b32 v11, 7, v0
    v_lshrrev_b32 v12, 4, v0
    v_xor_b32 v11, v11, v12
    v_lshl_add_u32 v2, v11, 4, v10
    v_xor_b32_e64 v3, 64, v2
    v_add_u32 v3, 15360, v3
    v_add_u32 v4, 30720, v2
    v_add_u32 v5, 30720, v3
    v_lshrrev_b32 v10, 5, v0
    v_add_u32 v10, s51, v10
    v_lshrrev_b32 v11, 2, v10
    v_and_b32 v12, 31, v0
    v_lshrrev_b32 v13, 2, v12
    s_lshl_b32 s48, s71, 1
    v_subrev_u32 v14, s48, v13
    v_and_b32 v14, 7, v14
    v_lshl_add_u32 v11, v11, 3, v14
    v_and_b32 v10, 3, v10
    v_and_b32 v13, 1, v13
    v_lshlrev_b32_e64 v11, 10, v11
    v_lshl_add_u32 v11, v10, 8, v11
    v_and_b32_e64 v10, 3, v12
    v_lshl_add_u32 v11, v10, 4, v11
    v_lshl_add_u32 v11, v13, 6, v11
    v_add_u32 v7, 98304, v11
    v_xor_b32 v8, 64, v7
    v_lshlrev_b32 v9, 3, v12
    v_add_u32 v9, 131072, v9
    s_mov_b32 s56, 0xffff0000
    s_mov_b32 s61, 0
    v_add_u32 v10, s69, v9
    s_waitcnt vmcnt(8)
    s_barrier
    ds_read_b64 v[40:41], v10
    ds_read_b64 v[42:43], v10 offset:4096
    s_waitcnt lgkmcnt(0)
    s_mov_b32 s52, s68
    s_and_b32 s60, s58, 15
    s_lshr_b64 s[58:59], s[58:59], 4
    s_mov_b32 m0, s70
    s_nop 0
    s_mul_i32 s54, s60, 917504
    s_lshl_b32 s68, s60, 7
    s_or_b32 s68, s68, s40
    buffer_load_dwordx4 v2, s[16:19], s52 offen lds
    v_lshlrev_b32 v16, 16, v40
    v_and_b32 v17, s56, v40
    v_lshlrev_b32 v18, 16, v41
    v_and_b32 v19, s56, v41
    v_lshlrev_b32 v20, 16, v42
    v_and_b32 v21, s56, v42
    buffer_load_dwordx4 v3, s[16:19], s52 offen offset:1024 lds
    v_lshlrev_b32 v22, 16, v43
    v_and_b32 v23, s56, v43
    v_mul_f32_e64 v20, -v20, v16
    v_mul_f32_e64 v21, -v21, v17
    v_mul_f32_e64 v22, -v22, v18
    v_mul_f32_e64 v23, -v23, v19
    s_lshl_b32 s48, s60, 8
    v_add_u32 v10, s48, v9
    ds_read_b64 v[40:41], v10
    ds_read_b64 v[42:43], v10 offset:4096
    buffer_load_dwordx4 v4, s[16:19], s52 offen offset:2048 lds
    s_waitcnt vmcnt(9)
    v_cvt_f32_i32 v52, v52
    v_cvt_f32_i32 v56, v56
    v_cvt_f32_i32 v53, v53
    v_cvt_f32_i32 v57, v57
    v_cvt_f32_i32 v54, v54
    v_cvt_f32_i32_e64 v58, v58
    buffer_load_dwordx4 v5, s[16:19], s52 offen offset:3072 lds
    v_cvt_f32_i32 v55, v55
    v_cvt_f32_i32 v59, v59
    v_fma_f32 v52, v52, v16, v20
    v_fma_f32 v56, v56, v16, v20
    v_fma_f32 v53, v53, v17, v21
    v_fma_f32 v57, v57, v17, v21
    s_add_u32 m0, s70, 4096
    s_xor_b32 s53, s52, 65536
    buffer_load_dwordx4 v2, s[16:19], s53 offen lds
    v_fma_f32 v54, v54, v18, v22
    v_fma_f32 v58, v58, v18, v22
    v_fma_f32 v55, v55, v19, v23
    v_fma_f32 v59, v59, v19, v23
    v_cvt_pk_bf16_f32 v120, v52, v56
    v_cvt_pk_bf16_f32 v124, v53, v57
    buffer_load_dwordx4 v3, s[16:19], s53 offen offset:1024 lds
    v_cvt_pk_bf16_f32 v128, v54, v58
    v_cvt_pk_bf16_f32 v132, v55, v59
    s_waitcnt vmcnt(10)
    v_cvt_f32_i32 v60, v60
    v_cvt_f32_i32 v64, v64
    v_cvt_f32_i32 v61, v61
    v_cvt_f32_i32_e64 v65, v65
    buffer_load_dwordx4 v4, s[16:19], s53 offen offset:2048 lds
    v_cvt_f32_i32 v62, v62
    v_cvt_f32_i32 v66, v66
    v_cvt_f32_i32 v63, v63
    v_cvt_f32_i32 v67, v67
    v_fma_f32 v60, v60, v16, v20
    v_fma_f32 v64, v64, v16, v20
    buffer_load_dwordx4 v5, s[16:19], s53 offen offset:3072 lds
    s_add_u32 s70, s70, 32768
    s_cmp_ge_u32 s70, 98304
    s_cselect_b32 s49, 98304, 0
    s_sub_u32 s70, s70, s49
    s_nop 0
    v_fma_f32 v61, v61, v17, v21
    v_fma_f32 v65, v65, v17, v21
    v_fma_f32 v62, v62, v18, v22
    v_fma_f32 v66, v66, v18, v22
    v_fma_f32 v63, v63, v19, v23
    v_fma_f32 v67, v67, v19, v23
    buffer_load_dwordx4 v[84:87], v44, s[20:23], s54 offen
    v_cvt_pk_bf16_f32 v121, v60, v64
    v_cvt_pk_bf16_f32 v125, v61, v65
    v_cvt_pk_bf16_f32 v129, v62, v66
    v_cvt_pk_bf16_f32 v133, v63, v67
    s_waitcnt vmcnt(11)
    v_cvt_f32_i32 v68, v68
    v_cvt_f32_i32_e64 v72, v72
    buffer_load_dwordx4 v[88:91], v45, s[20:23], s54 offen
    v_cvt_f32_i32 v69, v69
    v_cvt_f32_i32 v73, v73
    v_cvt_f32_i32 v70, v70
    v_cvt_f32_i32 v74, v74
    v_cvt_f32_i32 v71, v71
    v_cvt_f32_i32 v75, v75
    buffer_load_dwordx4 v[92:95], v46, s[20:23], s54 offen
    v_fma_f32 v68, v68, v16, v20
    v_fma_f32 v72, v72, v16, v20
    v_fma_f32 v69, v69, v17, v21
    v_fma_f32 v73, v73, v17, v21
    v_fma_f32 v70, v70, v18, v22
    v_fma_f32 v74, v74, v18, v22
    buffer_load_dwordx4 v[96:99], v47, s[20:23], s54 offen
    v_fma_f32 v71, v71, v19, v23
    v_fma_f32 v75, v75, v19, v23
    v_cvt_pk_bf16_f32 v122, v68, v72
    v_cvt_pk_bf16_f32 v126, v69, v73
    v_cvt_pk_bf16_f32 v130, v70, v74
    v_cvt_pk_bf16_f32 v134, v71, v75
    buffer_load_dwordx4 v[100:103], v48, s[20:23], s54 offen
    s_waitcnt vmcnt(13)
    v_cvt_f32_i32 v76, v76
    v_cvt_f32_i32 v80, v80
    v_cvt_f32_i32 v77, v77
    v_cvt_f32_i32 v81, v81
    v_cvt_f32_i32 v78, v78
    v_cvt_f32_i32_e64 v82, v82
    buffer_load_dwordx4 v[104:107], v49, s[20:23], s54 offen
    v_cvt_f32_i32 v79, v79
    v_cvt_f32_i32 v83, v83
    v_fma_f32 v76, v76, v16, v20
    v_fma_f32 v80, v80, v16, v20
    v_fma_f32 v77, v77, v17, v21
    v_fma_f32 v81, v81, v17, v21
    buffer_load_dwordx4 v[108:111], v50, s[20:23], s54 offen
    v_fma_f32 v78, v78, v18, v22
    v_fma_f32 v82, v82, v18, v22
    v_fma_f32 v79, v79, v19, v23
    v_fma_f32 v83, v83, v19, v23
    v_cvt_pk_bf16_f32 v123, v76, v80
    v_cvt_pk_bf16_f32 v127, v77, v81
    buffer_load_dwordx4 v[112:115], v51, s[20:23], s54 offen
    v_cvt_pk_bf16_f32 v131, v78, v82
    v_cvt_pk_bf16_f32 v135, v79, v83
    s_waitcnt lgkmcnt(0)
    s_nop 0
    s_nop 0
    s_nop 0
    s_nop 0
    s_nop 0
    s_nop 0
    s_nop 0
G_ploop:
    s_mov_b32 s52, s68
    s_and_b32 s60, s58, 15
    s_lshr_b64 s[58:59], s[58:59], 4
    s_mov_b32 m0, s70
    s_mul_i32 s54, s60, 917504
    s_lshl_b32 s68, s60, 7
    s_or_b32 s68, s68, s40
    buffer_load_dwordx4 v2, s[16:19], s52 offen lds
    v_lshlrev_b32 v16, 16, v40
    v_and_b32 v17, s56, v40
    ds_write_b128 v7, v[120:123]
    v_lshlrev_b32 v18, 16, v41
    v_and_b32 v19, s56, v41
    v_lshlrev_b32 v20, 16, v42
    v_and_b32 v21, s56, v42
    buffer_load_dwordx4 v3, s[16:19], s52 offen offset:1024 lds
    ds_write_b128 v8, v[124:127]
    v_lshlrev_b32 v22, 16, v43
    v_and_b32 v23, s56, v43
    v_mul_f32_e64 v20, -v20, v16
    v_mul_f32_e64 v21, -v21, v17
    ds_write_b128 v7, v[128:131] offset:128
    v_mul_f32_e64 v22, -v22, v18
    v_mul_f32_e64 v23, -v23, v19
    s_lshl_b32 s48, s60, 8
    v_add_u32 v10, s48, v9
    ds_read_b64 v[40:41], v10
    ds_read_b64 v[42:43], v10 offset:4096
    buffer_load_dwordx4 v4, s[16:19], s52 offen offset:2048 lds
    s_waitcnt vmcnt(9)
    v_cvt_f32_i32 v84, v84
    v_cvt_f32_i32_e64 v88, v88
    ds_write_b128 v8, v[132:135] offset:128
    v_cvt_f32_i32 v85, v85
    v_cvt_f32_i32 v89, v89
    v_cvt_f32_i32 v86, v86
    v_cvt_f32_i32 v90, v90
    buffer_load_dwordx4 v5, s[16:19], s52 offen offset:3072 lds
    v_cvt_f32_i32 v87, v87
    v_cvt_f32_i32 v91, v91
    v_fma_f32 v84, v84, v16, v20
    v_fma_f32 v88, v88, v16, v20
    v_fma_f32 v85, v85, v17, v21
    v_fma_f32 v89, v89, v17, v21
    s_add_u32 m0, s70, 4096
    s_xor_b32 s53, s52, 65536
    buffer_load_dwordx4 v2, s[16:19], s53 offen lds
    v_fma_f32 v86, v86, v18, v22
    v_fma_f32 v90, v90, v18, v22
    v_fma_f32 v87, v87, v19, v23
    v_fma_f32 v91, v91, v19, v23
    v_cvt_pk_bf16_f32 v136, v84, v88
    v_cvt_pk_bf16_f32 v140, v85, v89
    buffer_load_dwordx4 v3, s[16:19], s53 offen offset:1024 lds
    v_cvt_pk_bf16_f32 v144, v86, v90
    v_cvt_pk_bf16_f32 v148, v87, v91
    s_waitcnt vmcnt(10)
    v_cvt_f32_i32 v92, v92
    v_cvt_f32_i32 v96, v96
    v_cvt_f32_i32 v93, v93
    v_cvt_f32_i32_e64 v97, v97
    buffer_load_dwordx4 v4, s[16:19], s53 offen offset:2048 lds
    v_cvt_f32_i32 v94, v94
    v_cvt_f32_i32 v98, v98
    v_cvt_f32_i32 v95, v95
    v_cvt_f32_i32 v99, v99
    v_fma_f32 v92, v92, v16, v20
    v_fma_f32 v96, v96, v16, v20
    buffer_load_dwordx4 v5, s[16:19], s53 offen offset:3072 lds
    s_add_u32 s70, s70, 32768
    s_cmp_ge_u32 s70, 98304
    s_cselect_b32 s49, 98304, 0
    s_sub_u32 s70, s70, s49
    s_nop 0
    v_fma_f32 v93, v93, v17, v21
    v_fma_f32 v97, v97, v17, v21
    v_fma_f32 v94, v94, v18, v22
    v_fma_f32 v98, v98, v18, v22
    v_fma_f32 v95, v95, v19, v23
    v_fma_f32 v99, v99, v19, v23
    buffer_load_dwordx4 v[52:55], v44, s[20:23], s54 offen
    v_cvt_pk_bf16_f32 v137, v92, v96
    v_cvt_pk_bf16_f32 v141, v93, v97
    v_cvt_pk_bf16_f32 v145, v94, v98
    v_cvt_pk_bf16_f32 v149, v95, v99
    s_waitcnt vmcnt(11)
    v_cvt_f32_i32 v100, v100
    v_cvt_f32_i32_e64 v104, v104
    buffer_load_dwordx4 v[56:59], v45, s[20:23], s54 offen
    v_cvt_f32_i32 v101, v101
    v_cvt_f32_i32 v105, v105
    v_cvt_f32_i32 v102, v102
    v_cvt_f32_i32 v106, v106
    v_cvt_f32_i32 v103, v103
    v_cvt_f32_i32 v107, v107
    buffer_load_dwordx4 v[60:63], v46, s[20:23], s54 offen
    v_fma_f32 v100, v100, v16, v20
    v_fma_f32 v104, v104, v16, v20
    v_fma_f32 v101, v101, v17, v21
    v_fma_f32 v105, v105, v17, v21
    v_fma_f32 v102, v102, v18, v22
    v_fma_f32 v106, v106, v18, v22
    buffer_load_dwordx4 v[64:67], v47, s[20:23], s54 offen
    v_fma_f32 v103, v103, v19, v23
    v_fma_f32 v107, v107, v19, v23
    v_cvt_pk_bf16_f32 v138, v100, v104
    v_cvt_pk_bf16_f32 v142, v101, v105
    v_cvt_pk_bf16_f32 v146, v102, v106
    v_cvt_pk_bf16_f32 v150, v103, v107
    buffer_load_dwordx4 v[68:71], v48, s[20:23], s54 offen
    s_waitcnt vmcnt(13)
    v_cvt_f32_i32 v108, v108
    v_cvt_f32_i32 v112, v112
    v_cvt_f32_i32 v109, v109
    v_cvt_f32_i32 v113, v113
    v_cvt_f32_i32 v110, v110
    v_cvt_f32_i32_e64 v114, v114
    buffer_load_dwordx4 v[72:75], v49, s[20:23], s54 offen
    v_cvt_f32_i32 v111, v111
    v_cvt_f32_i32 v115, v115
    v_fma_f32 v108, v108, v16, v20
    v_fma_f32 v112, v112, v16, v20
    v_fma_f32 v109, v109, v17, v21
    v_fma_f32 v113, v113, v17, v21
    buffer_load_dwordx4 v[76:79], v50, s[20:23], s54 offen
    v_fma_f32 v110, v110, v18, v22
    v_fma_f32 v114, v114, v18, v22
    v_fma_f32 v111, v111, v19, v23
    v_fma_f32 v115, v115, v19, v23
    v_cvt_pk_bf16_f32 v139, v108, v112
    v_cvt_pk_bf16_f32 v143, v109, v113
    buffer_load_dwordx4 v[80:83], v51, s[20:23], s54 offen
    v_cvt_pk_bf16_f32 v147, v110, v114
    v_cvt_pk_bf16_f32 v151, v111, v115
    s_add_u32 s61, s61, 1
    s_waitcnt lgkmcnt(0)
    s_barrier
    s_mov_b32 s52, s68
    s_and_b32 s60, s58, 15
    s_lshr_b64 s[58:59], s[58:59], 4
    s_mov_b32 m0, s70
    s_nop 0
    s_mul_i32 s54, s60, 917504
    s_lshl_b32 s68, s60, 7
    s_or_b32 s68, s68, s40
    buffer_load_dwordx4 v2, s[16:19], s52 offen lds
    v_lshlrev_b32 v16, 16, v40
    v_and_b32 v17, s56, v40
    ds_write_b128 v7, v[136:139] offset:16384
    v_lshlrev_b32 v18, 16, v41
    v_and_b32 v19, s56, v41
    v_lshlrev_b32 v20, 16, v42
    v_and_b32 v21, s56, v42
    buffer_load_dwordx4 v3, s[16:19], s52 offen offset:1024 lds
    ds_write_b128 v8, v[140:143] offset:16384
    v_lshlrev_b32 v22, 16, v43
    v_and_b32 v23, s56, v43
    v_mul_f32_e64 v20, -v20, v16
    v_mul_f32_e64 v21, -v21, v17
    ds_write_b128 v7, v[144:147] offset:16512
    v_mul_f32_e64 v22, -v22, v18
    v_mul_f32_e64 v23, -v23, v19
    s_lshl_b32 s48, s60, 8
    v_add_u32 v10, s48, v9
    ds_read_b64 v[40:41], v10
    ds_read_b64 v[42:43], v10 offset:4096
    buffer_load_dwordx4 v4, s[16:19], s52 offen offset:2048 lds
    s_waitcnt vmcnt(9)
    v_cvt_f32_i32 v52, v52
    v_cvt_f32_i32_e64 v56, v56
    ds_write_b128 v8, v[148:151] offset:16512
    v_cvt_f32_i32 v53, v53
    v_cvt_f32_i32 v57, v57
    v_cvt_f32_i32 v54, v54
    v_cvt_f32_i32 v58, v58
    buffer_load_dwordx4 v5, s[16:19], s52 offen offset:3072 lds
    v_cvt_f32_i32 v55, v55
    v_cvt_f32_i32 v59, v59
    v_fma_f32 v52, v52, v16, v20
    v_fma_f32 v56, v56, v16, v20
    v_fma_f32 v53, v53, v17, v21
    v_fma_f32 v57, v57, v17, v21
    s_add_u32 m0, s70, 4096
    s_xor_b32 s53, s52, 65536
    buffer_load_dwordx4 v2, s[16:19], s53 offen lds
    v_fma_f32 v54, v54, v18, v22
    v_fma_f32 v58, v58, v18, v22
    v_fma_f32 v55, v55, v19, v23
    v_fma_f32 v59, v59, v19, v23
    v_cvt_pk_bf16_f32 v120, v52, v56
    v_cvt_pk_bf16_f32 v124, v53, v57
    buffer_load_dwordx4 v3, s[16:19], s53 offen offset:1024 lds
    v_cvt_pk_bf16_f32 v128, v54, v58
    v_cvt_pk_bf16_f32 v132, v55, v59
    s_waitcnt vmcnt(10)
    v_cvt_f32_i32 v60, v60
    v_cvt_f32_i32 v64, v64
    v_cvt_f32_i32 v61, v61
    v_cvt_f32_i32_e64 v65, v65
    buffer_load_dwordx4 v4, s[16:19], s53 offen offset:2048 lds
    v_cvt_f32_i32 v62, v62
    v_cvt_f32_i32 v66, v66
    v_cvt_f32_i32 v63, v63
    v_cvt_f32_i32 v67, v67
    v_fma_f32 v60, v60, v16, v20
    v_fma_f32 v64, v64, v16, v20
    buffer_load_dwordx4 v5, s[16:19], s53 offen offset:3072 lds
    s_add_u32 s70, s70, 32768
    s_cmp_ge_u32 s70, 98304
    s_cselect_b32 s49, 98304, 0
    s_sub_u32 s70, s70, s49
    s_nop 0
    v_fma_f32 v61, v61, v17, v21
    v_fma_f32 v65, v65, v17, v21
    v_fma_f32 v62, v62, v18, v22
    v_fma_f32 v66, v66, v18, v22
    v_fma_f32 v63, v63, v19, v23
    v_fma_f32 v67, v67, v19, v23
    buffer_load_dwordx4 v[84:87], v44, s[20:23], s54 offen
    v_cvt_pk_bf16_f32 v121, v60, v64
    v_cvt_pk_bf16_f32 v125, v61, v65
    v_cvt_pk_bf16_f32 v129, v62, v66
    v_cvt_pk_bf16_f32 v133, v63, v67
    s_waitcnt vmcnt(11)
    v_cvt_f32_i32 v68, v68
    v_cvt_f32_i32_e64 v72, v72
    buffer_load_dwordx4 v[88:91], v45, s[20:23], s54 offen
    v_cvt_f32_i32 v69, v69
    v_cvt_f32_i32 v73, v73
    v_cvt_f32_i32 v70, v70
    v_cvt_f32_i32 v74, v74
    v_cvt_f32_i32 v71, v71
    v_cvt_f32_i32 v75, v75
    buffer_load_dwordx4 v[92:95], v46, s[20:23], s54 offen
    v_fma_f32 v68, v68, v16, v20
    v_fma_f32 v72, v72, v16, v20
    v_fma_f32 v69, v69, v17, v21
    v_fma_f32 v73, v73, v17, v21
    v_fma_f32 v70, v70, v18, v22
    v_fma_f32 v74, v74, v18, v22
    buffer_load_dwordx4 v[96:99], v47, s[20:23], s54 offen
    v_fma_f32 v71, v71, v19, v23
    v_fma_f32 v75, v75, v19, v23
    v_cvt_pk_bf16_f32 v122, v68, v72
    v_cvt_pk_bf16_f32 v126, v69, v73
    v_cvt_pk_bf16_f32 v130, v70, v74
    v_cvt_pk_bf16_f32 v134, v71, v75
    buffer_load_dwordx4 v[100:103], v48, s[20:23], s54 offen
    s_waitcnt vmcnt(13)
    v_cvt_f32_i32 v76, v76
    v_cvt_f32_i32 v80, v80
    v_cvt_f32_i32 v77, v77
    v_cvt_f32_i32 v81, v81
    v_cvt_f32_i32 v78, v78
    v_cvt_f32_i32_e64 v82, v82
    buffer_load_dwordx4 v[104:107], v49, s[20:23], s54 offen
    v_cvt_f32_i32 v79, v79
    v_cvt_f32_i32 v83, v83
    v_fma_f32 v76, v76, v16, v20
    v_fma_f32 v80, v80, v16, v20
    v_fma_f32 v77, v77, v17, v21
    v_fma_f32 v81, v81, v17, v21
    buffer_load_dwordx4 v[108:111], v50, s[20:23], s54 offen
    v_fma_f32 v78, v78, v18, v22
    v_fma_f32 v82, v82, v18, v22
    v_fma_f32 v79, v79, v19, v23
    v_fma_f32 v83, v83, v19, v23
    v_cvt_pk_bf16_f32 v123, v76, v80
    v_cvt_pk_bf16_f32 v127, v77, v81
    buffer_load_dwordx4 v[112:115], v51, s[20:23], s54 offen
    v_cvt_pk_bf16_f32 v131, v78, v82
    v_cvt_pk_bf16_f32 v135, v79, v83
    s_add_u32 s61, s61, 1
    s_cmp_lt_u32 s61, 14
    s_waitcnt lgkmcnt(0)
    s_barrier
    s_cbranch_scc1 G_ploop
    s_mov_b32 s52, s68
    s_mov_b32 m0, s70
    s_nop 0
    buffer_load_dwordx4 v2, s[16:19], s52 offen lds
    v_lshlrev_b32 v16, 16, v40
    v_and_b32 v17, s56, v40
    ds_write_b128 v7, v[120:123]
    v_lshlrev_b32 v18, 16, v41
    v_and_b32 v19, s56, v41
    v_lshlrev_b32 v20, 16, v42
    v_and_b32 v21, s56, v42
    buffer_load_dwordx4 v3, s[16:19], s52 offen offset:1024 lds
    ds_write_b128 v8, v[124:127]
    v_lshlrev_b32 v22, 16, v43
    v_and_b32 v23, s56, v43
    v_mul_f32_e64 v20, -v20, v16
    v_mul_f32_e64 v21, -v21, v17
    ds_write_b128 v7, v[128:131] offset:128
    v_mul_f32_e64 v22, -v22, v18
    v_mul_f32_e64 v23, -v23, v19
    buffer_load_dwordx4 v4, s[16:19], s52 offen offset:2048 lds
    s_waitcnt vmcnt(9)
    v_cvt_f32_i32 v84, v84
    v_cvt_f32_i32_e64 v88, v88
    ds_write_b128 v8, v[132:135] offset:128
    v_cvt_f32_i32 v85, v85
    v_cvt_f32_i32 v89, v89
    v_cvt_f32_i32 v86, v86
    v_cvt_f32_i32 v90, v90
    buffer_load_dwordx4 v5, s[16:19], s52 offen offset:3072 lds
    v_cvt_f32_i32 v87, v87
    v_cvt_f32_i32 v91, v91
    v_fma_f32 v84, v84, v16, v20
    v_fma_f32 v88, v88, v16, v20
    v_fma_f32 v85, v85, v17, v21
    v_fma_f32 v89, v89, v17, v21
    s_add_u32 m0, s70, 4096
    s_xor_b32 s53, s52, 65536
    buffer_load_dwordx4 v2, s[16:19], s53 offen lds
    v_fma_f32 v86, v86, v18, v22
    v_fma_f32 v90, v90, v18, v22
    v_fma_f32 v87, v87, v19, v23
    v_fma_f32 v91, v91, v19, v23
    v_cvt_pk_bf16_f32 v136, v84, v88
    v_cvt_pk_bf16_f32 v140, v85, v89
    buffer_load_dwordx4 v3, s[16:19], s53 offen offset:1024 lds
    v_cvt_pk_bf16_f32 v144, v86, v90
    v_cvt_pk_bf16_f32 v148, v87, v91
    s_waitcnt vmcnt(10)
    v_cvt_f32_i32 v92, v92
    v_cvt_f32_i32 v96, v96
    v_cvt_f32_i32 v93, v93
    v_cvt_f32_i32_e64 v97, v97
    buffer_load_dwordx4 v4, s[16:19], s53 offen offset:2048 lds
    v_cvt_f32_i32 v94, v94
    v_cvt_f32_i32 v98, v98
    v_cvt_f32_i32 v95, v95
    v_cvt_f32_i32 v99, v99
    v_fma_f32 v92, v92, v16, v20
    v_fma_f32 v96, v96, v16, v20
    buffer_load_dwordx4 v5, s[16:19], s53 offen offset:3072 lds
    s_add_u32 s70, s70, 32768
    s_cmp_ge_u32 s70, 98304
    s_cselect_b32 s49, 98304, 0
    s_sub_u32 s70, s70, s49
    s_nop 0
    v_fma_f32 v93, v93, v17, v21
    v_fma_f32 v97, v97, v17, v21
    v_fma_f32 v94, v94, v18, v22
    v_fma_f32 v98, v98, v18, v22
    v_fma_f32 v95, v95, v19, v23
    v_fma_f32 v99, v99, v19, v23
    v_cvt_pk_bf16_f32 v137, v92, v96
    v_cvt_pk_bf16_f32 v141, v93, v97
    v_cvt_pk_bf16_f32 v145, v94, v98
    v_cvt_pk_bf16_f32 v149, v95, v99
    s_waitcnt vmcnt(10)
    v_cvt_f32_i32 v100, v100
    v_cvt_f32_i32 v104, v104
    v_cvt_f32_i32 v101, v101
    v_cvt_f32_i32 v105, v105
    v_cvt_f32_i32 v102, v102
    v_cvt_f32_i32 v106, v106
    v_cvt_f32_i32 v103, v103
    v_cvt_f32_i32_e64 v107, v107
    v_fma_f32 v100, v100, v16, v20
    v_fma_f32 v104, v104, v16, v20
    v_fma_f32 v101, v101, v17, v21
    v_fma_f32 v105, v105, v17, v21
    v_fma_f32 v102, v102, v18, v22
    v_fma_f32 v106, v106, v18, v22
    v_fma_f32 v103, v103, v19, v23
    v_fma_f32 v107, v107, v19, v23
    v_cvt_pk_bf16_f32 v138, v100, v104
    v_cvt_pk_bf16_f32 v142, v101, v105
    v_cvt_pk_bf16_f32 v146, v102, v106
    v_cvt_pk_bf16_f32 v150, v103, v107
    s_waitcnt vmcnt(8)
    v_cvt_f32_i32 v108, v108
    v_cvt_f32_i32 v112, v112
    v_cvt_f32_i32 v109, v109
    v_cvt_f32_i32 v113, v113
    v_cvt_f32_i32 v110, v110
    v_cvt_f32_i32 v114, v114
    v_cvt_f32_i32 v111, v111
    v_cvt_f32_i32_e64 v115, v115
    v_fma_f32 v108, v108, v16, v20
    v_fma_f32 v112, v112, v16, v20
    v_fma_f32 v109, v109, v17, v21
    v_fma_f32 v113, v113, v17, v21
    v_fma_f32 v110, v110, v18, v22
    v_fma_f32 v114, v114, v18, v22
    v_fma_f32 v111, v111, v19, v23
    v_fma_f32 v115, v115, v19, v23
    v_cvt_pk_bf16_f32 v139, v108, v112
    v_cvt_pk_bf16_f32 v143, v109, v113
    v_cvt_pk_bf16_f32 v147, v110, v114
    v_cvt_pk_bf16_f32 v151, v111, v115
    s_add_u32 s61, s61, 1
    s_waitcnt lgkmcnt(0)
    s_barrier
    s_nop 0
    ds_write_b128 v7, v[136:139] offset:16384
    ds_write_b128 v8, v[140:143] offset:16384
    ds_write_b128 v7, v[144:147] offset:16512
    ds_write_b128 v8, v[148:151] offset:16512
    s_add_u32 s61, s61, 1
    s_waitcnt vmcnt(0) lgkmcnt(0)
    s_barrier
    v_lshrrev_b32 v10, 4, v0
    v_and_b32_e64 v11, 15, v0
    v_mul_u32_u24 v12, 272, v10
    v_lshl_add_u32 v12, v11, 4, v12
    s_lshl_b32 s48, s47, 13
    s_nop 0
    s_add_u32 s48, s48, 32768
    s_mul_i32 s49, s47, 4352
    s_add_u32 s49, s49, 139264
    v_add_u32 v13, s48, v12
    v_add_u32 v14, s49, v12
    s_lshl_b32 s49, s45, 8
    s_lshl_b32 s50, s47, 6
    s_add_u32 s49, s49, s50
    s_lshl_b32 s50, s71, 5
    s_add_u32 s49, s49, s50
    s_nop 0
    s_mul_i32 s49, s49, 7168
    s_add_u32 s49, s49, s41
    s_lshl_b32 s50, s71, 2
    v_add_u32 v11, s50, v11
    v_and_b32 v11, 15, v11
    v_lshlrev_b32_e64 v11, 4, v11
    v_mul_u32_u24 v10, 7168, v10
    v_add3_u32 v15, v10, v11, s49
    s_mov_b32 s32, s12
    s_mov_b32 s33, s13
    s_mov_b32 s34, 14680064
    s_mov_b32 s35, 0x20000
    s_barrier
    s_nop 0
    ds_read_b128 v[52:55], v13
    ds_read_b128 v[56:59], v13 offset:1088
    ds_read_b128 v[60:63], v13 offset:2176
    ds_read_b128 v[64:67], v13 offset:3264
    s_mov_b32 s48, 0
    s_waitcnt lgkmcnt(3)
    buffer_store_dwordx4 v[52:55], v15, s[32:35], s48 offen sc1
    s_mov_b32 s49, 28672
    s_waitcnt lgkmcnt(2)
    s_nop 0
    buffer_store_dwordx4 v[56:59], v15, s[32:35], s49 offen sc1
    s_mov_b32 s48, 57344
    s_waitcnt lgkmcnt(1)
    s_nop 0
    buffer_store_dwordx4 v[60:63], v15, s[32:35], s48 offen sc1
    s_mov_b32 s49, 86016
    s_waitcnt lgkmcnt(0)
    s_nop 0
    buffer_store_dwordx4 v[64:67], v15, s[32:35], s49 offen sc1
    s_barrier
    s_nop 0
    ds_read_b128 v[68:71], v14
    ds_read_b128 v[72:75], v14 offset:1088
    ds_read_b128 v[76:79], v14 offset:2176
    ds_read_b128 v[80:83], v14 offset:3264
    s_mov_b32 s48, 114688
    s_waitcnt lgkmcnt(3)
    s_nop 0
    buffer_store_dwordx4 v[68:71], v15, s[32:35], s48 offen sc1
    s_mov_b32 s49, 143360
    s_waitcnt lgkmcnt(2)
    s_nop 0
    buffer_store_dwordx4 v[72:75], v15, s[32:35], s49 offen sc1
    s_mov_b32 s48, 172032
    s_waitcnt lgkmcnt(1)
    s_nop 0
    buffer_store_dwordx4 v[76:79], v15, s[32:35], s48 offen sc1
    s_mov_b32 s49, 200704
    s_waitcnt lgkmcnt(0)
    s_nop 0
    buffer_store_dwordx4 v[80:83], v15, s[32:35], s49 offen sc1
    s_endpgm
    s_nop 0
G_consumer:
    s_barrier
    s_lshl_b32 s48, s44, 13
    v_and_b32 v240, 15, v0
    v_lshrrev_b32 v241, 4, v0
    v_lshrrev_b32 v242, 1, v240
    v_xor_b32 v242, v242, v241
    v_lshlrev_b32_e64 v242, 4, v242
    v_lshl_add_u32 v242, v240, 7, v242
    v_add_u32 v208, s48, v242
    v_xor_b32 v209, 64, v208
    v_and_b32 v242, 3, v240
    v_lshrrev_b32 v243, 2, v240
    v_lshl_add_u32 v242, v242, 2, v243
    v_lshlrev_b32_e64 v242, 4, v242
    v_lshl_add_u32 v242, v241, 8, v242
    v_add_u32 v212, 98304, v242
    v_xor_b32_e64 v213, 64, v212
    v_mul_u32_u24 v242, 272, v240
    v_lshl_add_u32 v242, v241, 3, v242
    v_add_u32_e64 v214, s48, v242
    s_mul_i32 s49, s44, 4352
    s_add_u32 s49, s49, 139264
    v_add_u32_e64 v216, s49, v242
    v_mul_u32_u24 v242, 208, v240
    v_lshl_add_u32 v242, v241, 3, v242
    v_add_u32_e64 v242, s48, v242
    v_add_u32 v215, 65536, v242
    v_lshrrev_b32 v240, 4, v0
    v_and_b32 v241, 15, v0
    v_mul_u32_u24 v242, 272, v240
    v_lshl_add_u32 v242, v241, 4, v242
    v_min_u32_e64 v243, 11, v241
    v_mul_u32_u24 v242, 208, v240
    v_lshl_add_u32 v242, v243, 4, v242
    v_add_u32_e64 v242, s48, v242
    v_add_u32 v217, 65536, v242
    s_lshl_b32 s49, s45, 8
    s_lshl_b32 s50, s44, 6
    s_add_u32 s49, s49, s50
    s_nop 0
    s_mul_i32 s49, s49, 7168
    s_add_u32 s49, s49, s41
    s_nop 0
    s_mul_i32 s50, s71, 229376
    s_sub_u32 s51, 229376, s50
    s_add_u32 s50, s50, s49
    s_add_u32 s51, s51, s49
    s_lshl_b32 s49, s71, 2
    v_add_u32 v242, s49, v241
    v_and_b32 v242, 15, v242
    v_lshlrev_b32 v242, 4, v242
    v_mul_u32_u24 v243, 7168, v240
    v_add3_u32 v218, v242, v243, s50
    v_add3_u32 v219, v242, v243, s51
    v_cmp_gt_u32_e64 vcc, 12, v241
    v_mov_b32 v240, 0x7f000000
    s_mov_b32 s61, 0
    s_nop 0
    s_mov_b32 s34, 14680064
    v_cndmask_b32_e64 v219, v240, v219, vcc
    s_mov_b32 s35, 0x20000
    s_mov_b32 s42, 0
    s_nop 0
    s_mov_b32 s14, 32768
    s_mov_b32 s15, 0xffff0000
    v_mov_b32 v1, 0
    v_mov_b32 v2, 0
    v_mov_b32 v3, 0
    v_mov_b32 v4, 0
    v_mov_b32 v5, 0
    v_mov_b32 v6, 0
    v_mov_b32 v7, 0
    v_mov_b32 v8, 0
    v_mov_b32 v9, 0
    v_mov_b32 v10, 0
    v_mov_b32 v11, 0
    v_mov_b32 v12, 0
    v_mov_b32 v13, 0
    v_mov_b32 v14, 0
    v_mov_b32 v15, 0
    v_mov_b32 v16, 0
    v_mov_b32 v17, 0
    v_mov_b32 v18, 0
    v_mov_b32 v19, 0
    v_mov_b32 v20, 0
    v_mov_b32 v21, 0
    v_mov_b32 v22, 0
    v_mov_b32 v23, 0
    v_mov_b32 v24, 0
    v_mov_b32 v25, 0
    v_mov_b32 v26, 0
    v_mov_b32 v27, 0
    v_mov_b32 v28, 0
    v_mov_b32 v29, 0
    v_mov_b32 v30, 0
    v_mov_b32 v31, 0
    v_mov_b32 v32, 0
    v_mov_b32 v33, 0
    v_mov_b32 v34, 0
    v_mov_b32 v35, 0
    v_mov_b32 v36, 0
    v_mov_b32 v37, 0
    v_mov_b32 v38, 0
    v_mov_b32 v39, 0
    v_mov_b32 v40, 0
    v_mov_b32 v41, 0
    v_mov_b32 v42, 0
    v_mov_b32 v43, 0
    v_mov_b32 v44, 0
    v_mov_b32 v45, 0
    v_mov_b32 v46, 0
    v_mov_b32 v47, 0
    v_mov_b32 v48, 0
    v_mov_b32 v49, 0
    v_mov_b32 v50, 0
    v_mov_b32 v51, 0
    v_mov_b32 v52, 0
    v_mov_b32 v53, 0
    v_mov_b32 v54, 0
    v_mov_b32 v55, 0
    v_mov_b32 v56, 0
    v_mov_b32 v57, 0
    v_mov_b32 v58, 0
    v_mov_b32 v59, 0
    v_mov_b32 v60, 0
    v_mov_b32 v61, 0
    v_mov_b32 v62, 0
    v_mov_b32 v63, 0
    v_mov_b32 v64, 0
    v_mov_b32 v65, 0
    v_mov_b32 v66, 0
    v_mov_b32 v67, 0
    v_mov_b32 v68, 0
    v_mov_b32 v69, 0
    v_mov_b32 v70, 0
    v_mov_b32 v71, 0
    v_mov_b32 v72, 0
    v_mov_b32 v73, 0
    v_mov_b32 v74, 0
    v_mov_b32 v75, 0
    v_mov_b32 v76, 0
    v_mov_b32 v77, 0
    v_mov_b32 v78, 0
    v_mov_b32 v79, 0
    v_mov_b32 v80, 0
    v_mov_b32 v81, 0
    v_mov_b32 v82, 0
    v_mov_b32 v83, 0
    v_mov_b32 v84, 0
    v_mov_b32 v85, 0
    v_mov_b32 v86, 0
    v_mov_b32 v87, 0
    v_mov_b32 v88, 0
    v_mov_b32 v89, 0
    v_mov_b32 v90, 0
    v_mov_b32 v91, 0
    v_mov_b32 v92, 0
    v_mov_b32 v93, 0
    v_mov_b32 v94, 0
    v_mov_b32 v95, 0
    v_mov_b32 v96, 0
    v_mov_b32 v97, 0
    v_mov_b32 v98, 0
    v_mov_b32 v99, 0
    v_mov_b32 v100, 0
    v_mov_b32 v101, 0
    v_mov_b32 v102, 0
    v_mov_b32 v103, 0
    v_mov_b32 v104, 0
    v_mov_b32 v105, 0
    v_mov_b32 v106, 0
    v_mov_b32 v107, 0
    v_mov_b32 v108, 0
    v_mov_b32 v109, 0
    v_mov_b32 v110, 0
    v_mov_b32 v111, 0
    v_mov_b32 v0, 0
    s_waitcnt lgkmcnt(0)
    s_mov_b32 s32, s12
    s_mov_b32 s33, s13
    s_barrier
    ds_read_b128 v[112:115], v212 offset:0
    ds_read_b128 v[116:119], v213 offset:1024
    ds_read_b128 v[144:147], v208
    ds_read_b128 v[120:123], v212 offset:2048
    ds_read_b128 v[148:151], v208 offset:2048
    ds_read_b128 v[124:127], v213 offset:3072
    ds_read_b128 v[152:155], v208 offset:4096
    ds_read_b128 v[128:131], v212 offset:4096
    ds_read_b128 v[156:159], v208 offset:6144
    ds_read_b128 v[132:135], v213 offset:5120
    ds_read_b128 v[136:139], v212 offset:6144
    ds_read_b128 v[140:143], v213 offset:7168
    s_nop 0
    s_nop 0
    s_nop 0
    s_nop 0
    s_nop 0
    s_nop 0
G_loop:
    s_waitcnt lgkmcnt(0)
    s_nop 0
    v_mfma_f32_16x16x32_bf16 v[0:3], v[112:115], v[144:147], v[0:3]
    ds_read_b128 v[160:163], v212 offset:8192
    v_mfma_f32_16x16x32_bf16 v[32:35], v[112:115], v[148:151], v[32:35]
    v_mfma_f32_16x16x32_bf16 v[64:67], v[112:115], v[152:155], v[64:67]
    ds_read_b128 v[164:167], v213 offset:9216
    v_mfma_f32_16x16x32_bf16 v[88:91], v[112:115], v[156:159], v[88:91]
    v_mfma_f32_16x16x32_bf16 v[92:95], v[116:119], v[156:159], v[92:95]
    ds_read_b128 v[192:195], v209
    v_mfma_f32_16x16x32_bf16 v[68:71], v[116:119], v[152:155], v[68:71]
    v_mfma_f32_16x16x32_bf16 v[36:39], v[116:119], v[148:151], v[36:39]
    ds_read_b128 v[168:171], v212 offset:10240
    v_mfma_f32_16x16x32_bf16 v[4:7], v[116:119], v[144:147], v[4:7]
    v_mfma_f32_16x16x32_bf16 v[8:11], v[120:123], v[144:147], v[8:11]
    ds_read_b128 v[196:199], v209 offset:2048
    v_mfma_f32_16x16x32_bf16 v[40:43], v[120:123], v[148:151], v[40:43]
    v_mfma_f32_16x16x32_bf16 v[72:75], v[120:123], v[152:155], v[72:75]
    ds_read_b128 v[172:175], v213 offset:11264
    v_mfma_f32_16x16x32_bf16 v[96:99], v[120:123], v[156:159], v[96:99]
    v_mfma_f32_16x16x32_bf16 v[100:103], v[124:127], v[156:159], v[100:103]
    ds_read_b128 v[200:203], v209 offset:4096
    v_mfma_f32_16x16x32_bf16 v[76:79], v[124:127], v[152:155], v[76:79]
    v_mfma_f32_16x16x32_bf16 v[44:47], v[124:127], v[148:151], v[44:47]
    ds_read_b128 v[176:179], v212 offset:12288
    v_mfma_f32_16x16x32_bf16 v[12:15], v[124:127], v[144:147], v[12:15]
    v_mfma_f32_16x16x32_bf16 v[16:19], v[128:131], v[144:147], v[16:19]
    ds_read_b128 v[204:207], v209 offset:6144
    v_mfma_f32_16x16x32_bf16 v[48:51], v[128:131], v[148:151], v[48:51]
    v_mfma_f32_16x16x32_bf16 v[80:83], v[128:131], v[152:155], v[80:83]
    ds_read_b128 v[180:183], v213 offset:13312
    v_mfma_f32_16x16x32_bf16 v[104:107], v[128:131], v[156:159], v[104:107]
    v_mfma_f32_16x16x32_bf16 v[108:111], v[132:135], v[156:159], v[108:111]
    ds_read_b128 v[184:187], v212 offset:14336
    v_mfma_f32_16x16x32_bf16 v[84:87], v[132:135], v[152:155], v[84:87]
    v_mfma_f32_16x16x32_bf16 v[52:55], v[132:135], v[148:151], v[52:55]
    ds_read_b128 v[188:191], v213 offset:15360
    v_mfma_f32_16x16x32_bf16 v[20:23], v[132:135], v[144:147], v[20:23]
    v_mfma_f32_16x16x32_bf16 v[24:27], v[136:139], v[144:147], v[24:27]
    v_mfma_f32_16x16x32_bf16 v[56:59], v[136:139], v[148:151], v[56:59]
    v_mfma_f32_16x16x32_bf16 v[60:63], v[140:143], v[148:151], v[60:63]
    v_mfma_f32_16x16x32_bf16 v[28:31], v[140:143], v[144:147], v[28:31]
    s_add_u32 s42, s42, 1
    s_cmp_eq_u32 s42, 3
    s_cselect_b32 s43, s15, s14
    s_cselect_b32 s42, 0, s42
    s_waitcnt lgkmcnt(0)
    s_barrier
    v_mfma_f32_16x16x32_bf16 v[0:3], v[160:163], v[192:195], v[0:3]
    v_xor_b32 v212, 16384, v212
    v_xor_b32 v213, 16384, v213
    v_add_u32_e64 v208, s43, v208
    v_mfma_f32_16x16x32_bf16 v[32:35], v[160:163], v[196:199], v[32:35]
    ds_read_b128 v[112:115], v212 offset:0
    v_mfma_f32_16x16x32_bf16 v[64:67], v[160:163], v[200:203], v[64:67]
    v_mfma_f32_16x16x32_bf16 v[88:91], v[160:163], v[204:207], v[88:91]
    ds_read_b128 v[116:119], v213 offset:1024
    v_mfma_f32_16x16x32_bf16 v[92:95], v[164:167], v[204:207], v[92:95]
    v_mfma_f32_16x16x32_bf16 v[68:71], v[164:167], v[200:203], v[68:71]
    ds_read_b128 v[144:147], v208
    v_mfma_f32_16x16x32_bf16 v[36:39], v[164:167], v[196:199], v[36:39]
    v_mfma_f32_16x16x32_bf16 v[4:7], v[164:167], v[192:195], v[4:7]
    ds_read_b128 v[120:123], v212 offset:2048
    v_mfma_f32_16x16x32_bf16 v[8:11], v[168:171], v[192:195], v[8:11]
    v_mfma_f32_16x16x32_bf16 v[40:43], v[168:171], v[196:199], v[40:43]
    ds_read_b128 v[148:151], v208 offset:2048
    v_mfma_f32_16x16x32_bf16 v[72:75], v[168:171], v[200:203], v[72:75]
    v_mfma_f32_16x16x32_bf16 v[96:99], v[168:171], v[204:207], v[96:99]
    ds_read_b128 v[124:127], v213 offset:3072
    v_mfma_f32_16x16x32_bf16 v[100:103], v[172:175], v[204:207], v[100:103]
    v_mfma_f32_16x16x32_bf16 v[76:79], v[172:175], v[200:203], v[76:79]
    ds_read_b128 v[152:155], v208 offset:4096
    v_mfma_f32_16x16x32_bf16 v[44:47], v[172:175], v[196:199], v[44:47]
    v_mfma_f32_16x16x32_bf16 v[12:15], v[172:175], v[192:195], v[12:15]
    ds_read_b128 v[128:131], v212 offset:4096
    v_mfma_f32_16x16x32_bf16 v[16:19], v[176:179], v[192:195], v[16:19]
    v_mfma_f32_16x16x32_bf16 v[48:51], v[176:179], v[196:199], v[48:51]
    ds_read_b128 v[156:159], v208 offset:6144
    v_mfma_f32_16x16x32_bf16 v[80:83], v[176:179], v[200:203], v[80:83]
    v_mfma_f32_16x16x32_bf16 v[104:107], v[176:179], v[204:207], v[104:107]
    ds_read_b128 v[132:135], v213 offset:5120
    v_mfma_f32_16x16x32_bf16 v[108:111], v[180:183], v[204:207], v[108:111]
    v_mfma_f32_16x16x32_bf16 v[84:87], v[180:183], v[200:203], v[84:87]
    ds_read_b128 v[136:139], v212 offset:6144
    v_mfma_f32_16x16x32_bf16 v[52:55], v[180:183], v[196:199], v[52:55]
    v_mfma_f32_16x16x32_bf16 v[20:23], v[180:183], v[192:195], v[20:23]
    ds_read_b128 v[140:143], v213 offset:7168
    v_mfma_f32_16x16x32_bf16 v[24:27], v[184:187], v[192:195], v[24:27]
    v_mfma_f32_16x16x32_bf16 v[56:59], v[184:187], v[196:199], v[56:59]
    v_mfma_f32_16x16x32_bf16 v[60:63], v[188:191], v[196:199], v[60:63]
    v_add_u32_e64 v209, s43, v209
    v_mfma_f32_16x16x32_bf16 v[28:31], v[188:191], v[192:195], v[28:31]
    s_add_u32 s61, s61, 1
    s_cmp_lt_u32 s61, 14
    s_cbranch_scc1 G_loop
    s_waitcnt lgkmcnt(9)
    v_mfma_f32_16x16x32_bf16 v[0:3], v[112:115], v[144:147], v[0:3]
    ds_read_b128 v[160:163], v212 offset:8192
    s_waitcnt lgkmcnt(8)
    s_nop 0
    v_mfma_f32_16x16x32_bf16 v[32:35], v[112:115], v[148:151], v[32:35]
    ds_read_b128 v[192:195], v209
    v_mfma_f32_16x16x32_bf16 v[36:39], v[116:119], v[148:151], v[36:39]
    ds_read_b128 v[164:167], v213 offset:9216
    v_mfma_f32_16x16x32_bf16 v[4:7], v[116:119], v[144:147], v[4:7]
    ds_read_b128 v[196:199], v209 offset:2048
    v_mfma_f32_16x16x32_bf16 v[8:11], v[120:123], v[144:147], v[8:11]
    ds_read_b128 v[168:171], v212 offset:10240
    v_mfma_f32_16x16x32_bf16 v[40:43], v[120:123], v[148:151], v[40:43]
    ds_read_b128 v[172:175], v213 offset:11264
    s_waitcnt lgkmcnt(12)
    s_nop 0
    v_mfma_f32_16x16x32_bf16 v[44:47], v[124:127], v[148:151], v[44:47]
    ds_read_b128 v[176:179], v212 offset:12288
    v_mfma_f32_16x16x32_bf16 v[12:15], v[124:127], v[144:147], v[12:15]
    ds_read_b128 v[180:183], v213 offset:13312
    s_waitcnt lgkmcnt(12)
    s_nop 0
    v_mfma_f32_16x16x32_bf16 v[16:19], v[128:131], v[144:147], v[16:19]
    ds_read_b128 v[184:187], v212 offset:14336
    v_mfma_f32_16x16x32_bf16 v[48:51], v[128:131], v[148:151], v[48:51]
    ds_read_b128 v[188:191], v213 offset:15360
    s_waitcnt lgkmcnt(12)
    s_nop 0
    v_mfma_f32_16x16x32_bf16 v[52:55], v[132:135], v[148:151], v[52:55]
    v_add_u32 v220, s15, v208
    v_add_u32 v221, s15, v209
    v_mfma_f32_16x16x32_bf16 v[20:23], v[132:135], v[144:147], v[20:23]
    v_xor_b32 v222, 16384, v212
    v_xor_b32 v223, 16384, v213
    s_waitcnt lgkmcnt(11)
    s_nop 0
    v_mfma_f32_16x16x32_bf16 v[24:27], v[136:139], v[144:147], v[24:27]
    v_mfma_f32_16x16x32_bf16 v[56:59], v[136:139], v[148:151], v[56:59]
    s_waitcnt lgkmcnt(10)
    s_nop 0
    v_mfma_f32_16x16x32_bf16 v[60:63], v[140:143], v[148:151], v[60:63]
    v_mfma_f32_16x16x32_bf16 v[28:31], v[140:143], v[144:147], v[28:31]
    s_barrier
    s_waitcnt lgkmcnt(8)
    v_mfma_f32_16x16x32_bf16 v[0:3], v[160:163], v[192:195], v[0:3]
    ds_read_b128 v[112:115], v222 offset:0
    s_waitcnt lgkmcnt(7)
    s_nop 0
    v_mfma_f32_16x16x32_bf16 v[32:35], v[160:163], v[196:199], v[32:35]
    ds_read_b128 v[144:147], v220
    v_mfma_f32_16x16x32_bf16 v[36:39], v[164:167], v[196:199], v[36:39]
    ds_read_b128 v[116:119], v223 offset:1024
    v_mfma_f32_16x16x32_bf16 v[4:7], v[164:167], v[192:195], v[4:7]
    ds_read_b128 v[148:151], v220 offset:2048
    s_waitcnt lgkmcnt(9)
    s_nop 0
    v_mfma_f32_16x16x32_bf16 v[8:11], v[168:171], v[192:195], v[8:11]
    ds_read_b128 v[120:123], v222 offset:2048
    v_mfma_f32_16x16x32_bf16 v[40:43], v[168:171], v[196:199], v[40:43]
    ds_read_b128 v[124:127], v223 offset:3072
    s_waitcnt lgkmcnt(10)
    s_nop 0
    v_mfma_f32_16x16x32_bf16 v[44:47], v[172:175], v[196:199], v[44:47]
    ds_read_b128 v[128:131], v222 offset:4096
    v_mfma_f32_16x16x32_bf16 v[12:15], v[172:175], v[192:195], v[12:15]
    ds_read_b128 v[132:135], v223 offset:5120
    s_waitcnt lgkmcnt(11)
    s_nop 0
    v_mfma_f32_16x16x32_bf16 v[16:19], v[176:179], v[192:195], v[16:19]
    ds_read_b128 v[136:139], v222 offset:6144
    v_mfma_f32_16x16x32_bf16 v[48:51], v[176:179], v[196:199], v[48:51]
    ds_read_b128 v[140:143], v223 offset:7168
    s_waitcnt lgkmcnt(12)
    s_nop 0
    v_mfma_f32_16x16x32_bf16 v[52:55], v[180:183], v[196:199], v[52:55]
    v_mfma_f32_16x16x32_bf16 v[20:23], v[180:183], v[192:195], v[20:23]
    s_waitcnt lgkmcnt(11)
    s_nop 0
    v_mfma_f32_16x16x32_bf16 v[24:27], v[184:187], v[192:195], v[24:27]
    v_mfma_f32_16x16x32_bf16 v[56:59], v[184:187], v[196:199], v[56:59]
    s_waitcnt lgkmcnt(10)
    s_nop 0
    v_mfma_f32_16x16x32_bf16 v[60:63], v[188:191], v[196:199], v[60:63]
    v_mfma_f32_16x16x32_bf16 v[28:31], v[188:191], v[192:195], v[28:31]
    s_waitcnt lgkmcnt(8)
    s_nop 0
    v_mfma_f32_16x16x32_bf16 v[0:3], v[112:115], v[144:147], v[0:3]
    ds_read_b128 v[160:163], v222 offset:8192
    s_waitcnt lgkmcnt(7)
    s_nop 0
    v_mfma_f32_16x16x32_bf16 v[32:35], v[112:115], v[148:151], v[32:35]
    ds_read_b128 v[192:195], v221
    v_mfma_f32_16x16x32_bf16 v[36:39], v[116:119], v[148:151], v[36:39]
    ds_read_b128 v[164:167], v223 offset:9216
    v_mfma_f32_16x16x32_bf16 v[4:7], v[116:119], v[144:147], v[4:7]
    ds_read_b128 v[196:199], v221 offset:2048
    s_waitcnt lgkmcnt(9)
    s_nop 0
    v_mfma_f32_16x16x32_bf16 v[8:11], v[120:123], v[144:147], v[8:11]
    ds_read_b128 v[168:171], v222 offset:10240
    v_mfma_f32_16x16x32_bf16 v[40:43], v[120:123], v[148:151], v[40:43]
    ds_read_b128 v[172:175], v223 offset:11264
    s_waitcnt lgkmcnt(10)
    s_nop 0
    v_mfma_f32_16x16x32_bf16 v[44:47], v[124:127], v[148:151], v[44:47]
    ds_read_b128 v[176:179], v222 offset:12288
    v_mfma_f32_16x16x32_bf16 v[12:15], v[124:127], v[144:147], v[12:15]
    ds_read_b128 v[180:183], v223 offset:13312
    s_waitcnt lgkmcnt(11)
    s_nop 0
    v_mfma_f32_16x16x32_bf16 v[16:19], v[128:131], v[144:147], v[16:19]
    ds_read_b128 v[184:187], v222 offset:14336
    v_mfma_f32_16x16x32_bf16 v[48:51], v[128:131], v[148:151], v[48:51]
    ds_read_b128 v[188:191], v223 offset:15360
    s_waitcnt lgkmcnt(12)
    s_nop 0
    v_mfma_f32_16x16x32_bf16 v[52:55], v[132:135], v[148:151], v[52:55]
    v_mfma_f32_16x16x32_bf16 v[20:23], v[132:135], v[144:147], v[20:23]
    s_waitcnt lgkmcnt(11)
    s_nop 0
    v_mfma_f32_16x16x32_bf16 v[24:27], v[136:139], v[144:147], v[24:27]
    v_mfma_f32_16x16x32_bf16 v[56:59], v[136:139], v[148:151], v[56:59]
    s_waitcnt lgkmcnt(10)
    s_nop 0
    v_mfma_f32_16x16x32_bf16 v[60:63], v[140:143], v[148:151], v[60:63]
    v_mfma_f32_16x16x32_bf16 v[28:31], v[140:143], v[144:147], v[28:31]
    s_waitcnt lgkmcnt(8)
    s_nop 0
    v_mfma_f32_16x16x32_bf16 v[0:3], v[160:163], v[192:195], v[0:3]
    ds_read_b128 v[112:115], v212 offset:0
    s_waitcnt lgkmcnt(8)
    s_nop 0
    v_mfma_f32_16x16x32_bf16 v[4:7], v[164:167], v[192:195], v[4:7]
    ds_read_b128 v[152:155], v208 offset:4096
    s_waitcnt lgkmcnt(7)
    s_nop 0
    v_mfma_f32_16x16x32_bf16 v[8:11], v[168:171], v[192:195], v[8:11]
    ds_read_b128 v[116:119], v213 offset:1024
    s_waitcnt lgkmcnt(7)
    s_nop 0
    v_mfma_f32_16x16x32_bf16 v[12:15], v[172:175], v[192:195], v[12:15]
    ds_read_b128 v[156:159], v208 offset:6144
    s_waitcnt lgkmcnt(7)
    s_nop 0
    v_mfma_f32_16x16x32_bf16 v[16:19], v[176:179], v[192:195], v[16:19]
    ds_read_b128 v[120:123], v212 offset:2048
    s_waitcnt lgkmcnt(7)
    s_nop 0
    v_mfma_f32_16x16x32_bf16 v[20:23], v[180:183], v[192:195], v[20:23]
    ds_read_b128 v[124:127], v213 offset:3072
    s_waitcnt lgkmcnt(7)
    s_nop 0
    v_mfma_f32_16x16x32_bf16 v[24:27], v[184:187], v[192:195], v[24:27]
    ds_read_b128 v[128:131], v212 offset:4096
    s_waitcnt lgkmcnt(7)
    s_nop 0
    v_mfma_f32_16x16x32_bf16 v[28:31], v[188:191], v[192:195], v[28:31]
    ds_read_b128 v[132:135], v213 offset:5120
    v_mfma_f32_16x16x32_bf16 v[32:35], v[160:163], v[196:199], v[32:35]
    v_cvt_pk_bf16_f32 v224, v0, v1
    v_cvt_pk_bf16_f32 v225, v2, v3
    ds_write_b64 v214, v[224:225] offset:32768
    v_mfma_f32_16x16x32_bf16 v[36:39], v[164:167], v[196:199], v[36:39]
    v_cvt_pk_bf16_f32 v226, v4, v5
    v_cvt_pk_bf16_f32 v227, v6, v7
    ds_write_b64 v214, v[226:227] offset:32800
    v_mfma_f32_16x16x32_bf16 v[40:43], v[168:171], v[196:199], v[40:43]
    v_cvt_pk_bf16_f32 v228, v8, v9
    v_cvt_pk_bf16_f32 v229, v10, v11
    ds_write_b64 v214, v[228:229] offset:32832
    v_mfma_f32_16x16x32_bf16 v[44:47], v[172:175], v[196:199], v[44:47]
    v_cvt_pk_bf16_f32 v230, v12, v13
    v_cvt_pk_bf16_f32 v231, v14, v15
    ds_write_b64 v214, v[230:231] offset:32864
    v_mfma_f32_16x16x32_bf16 v[48:51], v[176:179], v[196:199], v[48:51]
    v_cvt_pk_bf16_f32 v232, v16, v17
    v_cvt_pk_bf16_f32 v233, v18, v19
    ds_write_b64 v214, v[232:233] offset:32896
    v_mfma_f32_16x16x32_bf16 v[52:55], v[180:183], v[196:199], v[52:55]
    v_cvt_pk_bf16_f32 v234, v20, v21
    v_cvt_pk_bf16_f32 v235, v22, v23
    ds_write_b64 v214, v[234:235] offset:32928
    v_mfma_f32_16x16x32_bf16 v[56:59], v[184:187], v[196:199], v[56:59]
    v_cvt_pk_bf16_f32 v236, v24, v25
    v_cvt_pk_bf16_f32 v237, v26, v27
    ds_write_b64 v214, v[236:237] offset:32960
    v_mfma_f32_16x16x32_bf16 v[60:63], v[188:191], v[196:199], v[60:63]
    v_cvt_pk_bf16_f32 v238, v28, v29
    v_cvt_pk_bf16_f32 v239, v30, v31
    ds_write_b64 v214, v[238:239] offset:32992
    s_waitcnt lgkmcnt(0)
    s_barrier
    v_mfma_f32_16x16x32_bf16 v[64:67], v[112:115], v[152:155], v[64:67]
    ds_read_b128 v[160:163], v212 offset:8192
    v_cvt_pk_bf16_f32 v224, v32, v33
    v_cvt_pk_bf16_f32 v225, v34, v35
    ds_write_b64 v216, v[224:225]
    v_mfma_f32_16x16x32_bf16 v[88:91], v[112:115], v[156:159], v[88:91]
    ds_read_b128 v[200:203], v209 offset:4096
    v_cvt_pk_bf16_f32 v226, v36, v37
    v_cvt_pk_bf16_f32 v227, v38, v39
    ds_write_b64 v216, v[226:227] offset:32
    v_mfma_f32_16x16x32_bf16 v[92:95], v[116:119], v[156:159], v[92:95]
    ds_read_b128 v[164:167], v213 offset:9216
    v_cvt_pk_bf16_f32 v228, v40, v41
    v_cvt_pk_bf16_f32 v229, v42, v43
    ds_write_b64 v216, v[228:229] offset:64
    v_mfma_f32_16x16x32_bf16 v[68:71], v[116:119], v[152:155], v[68:71]
    ds_read_b128 v[204:207], v209 offset:6144
    v_cvt_pk_bf16_f32 v230, v44, v45
    v_cvt_pk_bf16_f32 v231, v46, v47
    ds_write_b64 v216, v[230:231] offset:96
    v_mfma_f32_16x16x32_bf16 v[72:75], v[120:123], v[152:155], v[72:75]
    ds_read_b128 v[168:171], v212 offset:10240
    v_cvt_pk_bf16_f32 v232, v48, v49
    v_cvt_pk_bf16_f32 v233, v50, v51
    ds_write_b64 v216, v[232:233] offset:128
    v_mfma_f32_16x16x32_bf16 v[96:99], v[120:123], v[156:159], v[96:99]
    ds_read_b128 v[172:175], v213 offset:11264
    v_cvt_pk_bf16_f32 v234, v52, v53
    v_cvt_pk_bf16_f32 v235, v54, v55
    ds_write_b64 v216, v[234:235] offset:160
    v_mfma_f32_16x16x32_bf16 v[100:103], v[124:127], v[156:159], v[100:103]
    ds_read_b128 v[176:179], v212 offset:12288
    v_cvt_pk_bf16_f32 v236, v56, v57
    v_cvt_pk_bf16_f32 v237, v58, v59
    ds_write_b64 v216, v[236:237] offset:192
    v_mfma_f32_16x16x32_bf16 v[76:79], v[124:127], v[152:155], v[76:79]
    ds_read_b128 v[180:183], v213 offset:13312
    v_cvt_pk_bf16_f32 v238, v60, v61
    v_cvt_pk_bf16_f32 v239, v62, v63
    ds_write_b64 v216, v[238:239] offset:224
    v_mfma_f32_16x16x32_bf16 v[80:83], v[128:131], v[152:155], v[80:83]
    v_mfma_f32_16x16x32_bf16 v[104:107], v[128:131], v[156:159], v[104:107]
    v_mfma_f32_16x16x32_bf16 v[108:111], v[132:135], v[156:159], v[108:111]
    v_mfma_f32_16x16x32_bf16 v[84:87], v[132:135], v[152:155], v[84:87]
    s_waitcnt lgkmcnt(0)
    s_barrier
    v_mfma_f32_16x16x32_bf16 v[64:67], v[160:163], v[200:203], v[64:67]
    ds_read_b128 v[112:115], v222 offset:0
    v_mfma_f32_16x16x32_bf16 v[88:91], v[160:163], v[204:207], v[88:91]
    ds_read_b128 v[152:155], v220 offset:4096
    v_mfma_f32_16x16x32_bf16 v[92:95], v[164:167], v[204:207], v[92:95]
    ds_read_b128 v[116:119], v223 offset:1024
    v_mfma_f32_16x16x32_bf16 v[68:71], v[164:167], v[200:203], v[68:71]
    ds_read_b128 v[156:159], v220 offset:6144
    v_mfma_f32_16x16x32_bf16 v[72:75], v[168:171], v[200:203], v[72:75]
    ds_read_b128 v[120:123], v222 offset:2048
    v_mfma_f32_16x16x32_bf16 v[96:99], v[168:171], v[204:207], v[96:99]
    ds_read_b128 v[124:127], v223 offset:3072
    v_mfma_f32_16x16x32_bf16 v[100:103], v[172:175], v[204:207], v[100:103]
    ds_read_b128 v[128:131], v222 offset:4096
    v_mfma_f32_16x16x32_bf16 v[76:79], v[172:175], v[200:203], v[76:79]
    ds_read_b128 v[132:135], v223 offset:5120
    v_mfma_f32_16x16x32_bf16 v[80:83], v[176:179], v[200:203], v[80:83]
    v_mfma_f32_16x16x32_bf16 v[104:107], v[176:179], v[204:207], v[104:107]
    v_mfma_f32_16x16x32_bf16 v[108:111], v[180:183], v[204:207], v[108:111]
    v_mfma_f32_16x16x32_bf16 v[84:87], v[180:183], v[200:203], v[84:87]
    s_waitcnt lgkmcnt(6)
    s_nop 0
    v_mfma_f32_16x16x32_bf16 v[64:67], v[112:115], v[152:155], v[64:67]
    ds_read_b128 v[160:163], v222 offset:8192
    s_waitcnt lgkmcnt(5)
    s_nop 0
    v_mfma_f32_16x16x32_bf16 v[88:91], v[112:115], v[156:159], v[88:91]
    ds_read_b128 v[200:203], v221 offset:4096
    v_mfma_f32_16x16x32_bf16 v[92:95], v[116:119], v[156:159], v[92:95]
    ds_read_b128 v[164:167], v223 offset:9216
    v_mfma_f32_16x16x32_bf16 v[68:71], v[116:119], v[152:155], v[68:71]
    ds_read_b128 v[204:207], v221 offset:6144
    s_waitcnt lgkmcnt(7)
    s_nop 0
    v_mfma_f32_16x16x32_bf16 v[72:75], v[120:123], v[152:155], v[72:75]
    ds_read_b128 v[168:171], v222 offset:10240
    v_mfma_f32_16x16x32_bf16 v[96:99], v[120:123], v[156:159], v[96:99]
    ds_read_b128 v[172:175], v223 offset:11264
    s_waitcnt lgkmcnt(8)
    s_nop 0
    v_mfma_f32_16x16x32_bf16 v[100:103], v[124:127], v[156:159], v[100:103]
    ds_read_b128 v[176:179], v222 offset:12288
    v_mfma_f32_16x16x32_bf16 v[76:79], v[124:127], v[152:155], v[76:79]
    ds_read_b128 v[180:183], v223 offset:13312
    s_waitcnt lgkmcnt(9)
    s_nop 0
    v_mfma_f32_16x16x32_bf16 v[80:83], v[128:131], v[152:155], v[80:83]
    v_mfma_f32_16x16x32_bf16 v[104:107], v[128:131], v[156:159], v[104:107]
    s_waitcnt lgkmcnt(8)
    s_nop 0
    v_mfma_f32_16x16x32_bf16 v[108:111], v[132:135], v[156:159], v[108:111]
    v_mfma_f32_16x16x32_bf16 v[84:87], v[132:135], v[152:155], v[84:87]
    s_waitcnt lgkmcnt(6)
    s_nop 0
    v_mfma_f32_16x16x32_bf16 v[64:67], v[160:163], v[200:203], v[64:67]
    s_waitcnt lgkmcnt(5)
    s_nop 0
    v_mfma_f32_16x16x32_bf16 v[68:71], v[164:167], v[200:203], v[68:71]
    s_waitcnt lgkmcnt(3)
    s_nop 0
    v_mfma_f32_16x16x32_bf16 v[72:75], v[168:171], v[200:203], v[72:75]
    s_waitcnt lgkmcnt(2)
    s_nop 0
    v_mfma_f32_16x16x32_bf16 v[76:79], v[172:175], v[200:203], v[76:79]
    s_waitcnt lgkmcnt(1)
    s_nop 0
    v_mfma_f32_16x16x32_bf16 v[80:83], v[176:179], v[200:203], v[80:83]
    s_waitcnt lgkmcnt(0)
    s_nop 0
    v_mfma_f32_16x16x32_bf16 v[84:87], v[180:183], v[200:203], v[84:87]
    v_mfma_f32_16x16x32_bf16 v[88:91], v[160:163], v[204:207], v[88:91]
    v_mfma_f32_16x16x32_bf16 v[92:95], v[164:167], v[204:207], v[92:95]
    v_mfma_f32_16x16x32_bf16 v[96:99], v[168:171], v[204:207], v[96:99]
    v_cvt_pk_bf16_f32 v224, v64, v65
    v_cvt_pk_bf16_f32 v225, v66, v67
    ds_write_b64 v215, v[224:225]
    v_mfma_f32_16x16x32_bf16 v[100:103], v[172:175], v[204:207], v[100:103]
    v_cvt_pk_bf16_f32 v226, v68, v69
    v_cvt_pk_bf16_f32 v227, v70, v71
    ds_write_b64 v215, v[226:227] offset:32
    v_mfma_f32_16x16x32_bf16 v[104:107], v[176:179], v[204:207], v[104:107]
    v_cvt_pk_bf16_f32 v228, v72, v73
    v_cvt_pk_bf16_f32 v229, v74, v75
    ds_write_b64 v215, v[228:229] offset:64
    v_mfma_f32_16x16x32_bf16 v[108:111], v[180:183], v[204:207], v[108:111]
    v_cvt_pk_bf16_f32 v230, v76, v77
    v_cvt_pk_bf16_f32 v231, v78, v79
    ds_write_b64 v215, v[230:231] offset:96
    v_cvt_pk_bf16_f32 v232, v80, v81
    v_cvt_pk_bf16_f32 v233, v82, v83
    ds_write_b64 v215, v[232:233] offset:128
    v_cvt_pk_bf16_f32 v234, v84, v85
    v_cvt_pk_bf16_f32 v235, v86, v87
    ds_write_b64 v215, v[234:235] offset:160
    ds_read_b128 v[0:3], v217
    ds_read_b128 v[4:7], v217 offset:832
    ds_read_b128 v[8:11], v217 offset:1664
    ds_read_b128 v[12:15], v217 offset:2496
    v_cvt_pk_bf16_f32 v236, v88, v89
    v_cvt_pk_bf16_f32 v237, v90, v91
    ds_write_b64 v215, v[236:237] offset:3328
    v_cvt_pk_bf16_f32 v238, v92, v93
    v_cvt_pk_bf16_f32 v239, v94, v95
    ds_write_b64 v215, v[238:239] offset:3360
    v_cvt_pk_bf16_f32 v224, v96, v97
    v_cvt_pk_bf16_f32 v225, v98, v99
    ds_write_b64 v215, v[224:225] offset:3392
    s_waitcnt lgkmcnt(6)
    s_mov_b32 s48, 0
    buffer_store_dwordx4 v[0:3], v219, s[32:35], s48 offen sc1
    v_cvt_pk_bf16_f32 v226, v100, v101
    v_cvt_pk_bf16_f32 v227, v102, v103
    ds_write_b64 v215, v[226:227] offset:3424
    s_waitcnt lgkmcnt(6)
    s_nop 0
    s_mov_b32 s49, 28672
    buffer_store_dwordx4 v[4:7], v219, s[32:35], s49 offen sc1
    v_cvt_pk_bf16_f32 v228, v104, v105
    v_cvt_pk_bf16_f32 v229, v106, v107
    ds_write_b64 v215, v[228:229] offset:3456
    s_waitcnt lgkmcnt(6)
    s_nop 0
    s_mov_b32 s48, 57344
    buffer_store_dwordx4 v[8:11], v219, s[32:35], s48 offen sc1
    v_cvt_pk_bf16_f32 v230, v108, v109
    v_cvt_pk_bf16_f32 v231, v110, v111
    ds_write_b64 v215, v[230:231] offset:3488
    s_waitcnt lgkmcnt(6)
    s_nop 0
    s_mov_b32 s49, 86016
    buffer_store_dwordx4 v[12:15], v219, s[32:35], s49 offen sc1
    ds_read_b128 v[16:19], v217 offset:3328
    ds_read_b128 v[20:23], v217 offset:4160
    ds_read_b128 v[24:27], v217 offset:4992
    ds_read_b128 v[28:31], v217 offset:5824
    s_waitcnt lgkmcnt(3)
    s_nop 0
    s_mov_b32 s48, 114688
    buffer_store_dwordx4 v[16:19], v219, s[32:35], s48 offen sc1
    s_waitcnt lgkmcnt(2)
    s_nop 0
    s_mov_b32 s49, 143360
    buffer_store_dwordx4 v[20:23], v219, s[32:35], s49 offen sc1
    s_waitcnt lgkmcnt(1)
    s_nop 0
    s_mov_b32 s48, 172032
    buffer_store_dwordx4 v[24:27], v219, s[32:35], s48 offen sc1
    s_waitcnt lgkmcnt(0)
    s_nop 0
    s_mov_b32 s49, 200704
    buffer_store_dwordx4 v[28:31], v219, s[32:35], s49 offen sc1
G_end:
    s_endpgm
.section .rodata,"a"
.p2align 6
.amdhsa_kernel standalone__weight_only_int_quip_2__prompt_kernel
  .amdhsa_next_free_vgpr 256
  .amdhsa_next_free_sgpr 102
  .amdhsa_accum_offset 256
  .amdhsa_group_segment_fixed_size 0
  .amdhsa_kernarg_size 56
  .amdhsa_user_sgpr_count 2
  .amdhsa_user_sgpr_kernarg_segment_ptr 1
  .amdhsa_system_sgpr_workgroup_id_x 1
  .amdhsa_float_denorm_mode_32 3
  .amdhsa_float_denorm_mode_16_64 3
.end_amdhsa_kernel
```
